```python
import torch

def _softmax(x, axis=-1):
    return torch.softmax(x, dim=axis)
def _gelu(x):
    return torch.nn.functional.gelu(x, approximate="tanh")
def _silu(x):
    return torch.nn.functional.silu(x)
def _sigmoid(x):
    return torch.sigmoid(x)
def _layernorm(x, axis=-1, eps=1e-5):
    m = x.mean(dim=axis, keepdim=True)
    v = x.var(dim=axis, keepdim=True, unbiased=False)
    return (x - m) / torch.sqrt(v + eps)
def _scatter_add(tgt, idx, src, axis=0):
    return tgt.clone().index_add_(axis, idx, src)
def _segment_sum(src, seg, n):
    out = torch.zeros((n,) + src.shape[1:], dtype=src.dtype)
    return out.index_add_(0, seg, src)
def _pad(x, pw):
    flat = tuple(v for pair in reversed(pw) for v in pair)
    return torch.nn.functional.pad(x, flat)

kernel_name = 'concat_heads__spectral_gfnet__linear_attn_block__prompt'

def setup_inputs():

    _w = (lambda a: (lambda t: t.to(torch.bfloat16) if t.is_floating_point() else t)(torch.as_tensor(a)))
    def _A_setup():
        B, S, D = 1, 2048, 512
        Df = D // 2 + 1
        return {
            "x": _w((lambda *s: torch.randn(*s, dtype=torch.bfloat16) * 0.05)(B, S, D)),
            "w_r": _w((lambda *s: torch.randn(*s, dtype=torch.bfloat16) * 1.6)(S, Df) * 0.02),
            "w_i": _w((lambda *s: torch.randn(*s, dtype=torch.bfloat16) * 1.6)(S, Df) * 0.02),
        }
    _A_in = _A_setup()

    def _B_setup():
        B, S, D = 1, 2048, 512
        return {
            "x": _w((lambda *s: torch.randn(*s, dtype=torch.bfloat16) * 0.05)(B, S, D)),
            "wqkv": _w((lambda *s: torch.randn(*s, dtype=torch.bfloat16) * 0.4)(D, 3 * D)),
            "wo": _w((lambda *s: torch.randn(*s, dtype=torch.bfloat16) * 0.05)(D, D)),
        }
    _B_in = _B_setup()

    return {
        "A_x": _A_in["x"],
        "A_w_r": _A_in["w_r"],
        "A_w_i": _A_in["w_i"],
        "B_x": _B_in["x"],
        "B_wqkv": _B_in["wqkv"],
        "B_wo": _B_in["wo"],
    }

def reference(A_x, A_w_r, A_w_i, B_x, B_wqkv, B_wo):
    def _A_ref(x, w_r, w_i):
        B, S, D = x.shape
        X = (lambda x, axes=(-2,-1): torch.fft.rfft2(x.float(), dim=axes))(x, axes=(-2, -1))
        W = w_r + 1j * w_i
        X = X * W
        y = (lambda x, s, axes=(-2,-1): torch.fft.irfft2(x, s=s, dim=axes).to(torch.bfloat16))(X, (S, D), axes=(-2, -1))
        return y

    def _B_ref(x, wqkv, wo):
        B, S, D = x.shape
        H = 32; Dh = D // H
        qkv = (lambda x, *d: x.permute(*d))((x @ wqkv).reshape(B, S, 3, H, Dh), 2, 0, 3, 1, 4)
        q, k, v = qkv[0], qkv[1], qkv[2]
        phi = lambda t: torch.where(t > 0, t + 1, torch.exp(t)) + 1e-6
        pq, pk = phi(q), phi(k)
        kv = torch.einsum("bhsd,bhse->bhde", pk, v)
        z = torch.einsum("bhsd->bhd", pk)
        num = torch.einsum("bhqd,bhde->bhqe", pq, kv)
        den = torch.einsum("bhqd,bhd->bhq", pq, z)[..., None] + 1e-6
        o = num / den
        return (lambda x, *d: x.permute(*d))(o, 0, 2, 1, 3).reshape(B, S, D) @ wo

    a = _A_ref(A_x, A_w_r, A_w_i)
    b = _B_ref(B_x, B_wqkv, B_wo)
    return torch.concatenate([a, b], axis=-1)
```

```asm
; @launch grid=(256,1,1) block=(512,1,1) lds=163840
.amdgcn_target "amdgcn-amd-amdhsa--gfx950"
.text
.globl concat_heads__spectral_gfnet__linear_attn_block__prompt_kernel
.p2align 8
.type concat_heads__spectral_gfnet__linear_attn_block__prompt_kernel,@function
concat_heads__spectral_gfnet__linear_attn_block__prompt_kernel:
    s_cmp_ge_u32 s2, 256
    s_cbranch_scc1 L_end
    s_load_dwordx16 s[4:19], s[0:1], 0
    s_load_dwordx2 s[20:21], s[0:1], 64
    v_and_b32 v1, 63, v0
    v_lshrrev_b32 v3, 6, v0
    v_lshlrev_b32 v127, 4, v1
    v_readfirstlane_b32 s56, v3
    s_and_b32 s70, s2, 7
    s_lshr_b32 s71, s2, 4
    s_and_b32 s63, s56, 3
    s_lshr_b32 s88, s56, 2
    s_bitcmp1_b32 s2, 3
    s_cbranch_scc1 L_roleA
    s_getpc_b64 s[22:23]
Lpf_1:
    v_lshlrev_b32 v2, 7, v0
    v_min_u32 v2, L_roleA-Lpf_1, v2
    global_load_dword v113, v2, s[22:23]
    s_lshr_b32 s59, s70, 1
    s_lshl_b32 s59, s59, 2
    s_and_b32 s72, s71, 3
    s_add_u32 s59, s59, s72
    s_and_b32 s60, s70, 1
    s_lshl_b32 s60, s60, 2
    s_lshr_b32 s72, s71, 2
    s_add_u32 s60, s60, s72
    s_mov_b32 s89, s72
    s_and_b32 s64, s70, 1
    s_lshl_b32 s72, s59, 1
    s_add_u32 s64, s64, s72
    s_lshl_b32 s64, s64, 1
    v_lshrrev_b32 v4, 2, v1
    v_and_b32 v5, 3, v1
    v_lshrrev_b32 v6, 4, v1
    v_lshrrev_b32 v7, 5, v1
    v_and_b32 v12, 15, v1
    s_cmp_lt_u32 s56, 4
    s_cbranch_scc1 L_bcomp
    v_lshrrev_b32 v8, 3, v1
    v_and_b32 v10, 7, v1
    v_xor_b32 v10, v10, v6
    v_lshlrev_b32 v10, 4, v10
    v_lshl_add_u32 v100, v8, 10, v10
    v_xor_b32 v10, 64, v100
    v_add_u32 v101, 7168, v10
    v_mul_u32_u24 v8, 3072, v8
    v_lshl_add_u32 v8, v5, 4, v8
    v_xor_b32 v9, v4, v6
    v_and_b32 v9, 1, v9
    v_lshl_add_u32 v102, v9, 6, v8
    s_lshl_b32 s74, s59, 2
    s_add_u32 s74, s74, s63
    s_lshl_b32 s74, s74, 15
    s_mul_i32 s75, s63, 24576
    s_lshl_b32 s73, s60, 7
    s_add_u32 s75, s75, s73
    s_lshl_b32 s79, s63, 12
    s_mul_i32 s61, s63, 3072
    s_waitcnt lgkmcnt(0)
    s_mov_b64 s[36:37], s[10:11]
    s_mov_b32 s38, 2097152
    s_mov_b32 s39, 0x20000
    s_mov_b64 s[40:41], s[12:13]
    s_mov_b32 s42, 1572864
    s_mov_b32 s43, 0x20000
    s_add_u32 m0, s79, 0
    s_add_u32 s69, s74, 0
    buffer_load_dwordx4 v100, s[36:39], s69 offen lds
    buffer_load_dwordx4 v101, s[36:39], s69 offen offset:1024 lds
    s_add_u32 m0, s61, 65536
    s_add_u32 s69, s75, 0
    buffer_load_dwordx4 v102, s[40:43], s69 offen lds
    buffer_load_dwordx4 v102, s[40:43], s69 offen offset:1024 lds
    buffer_load_dwordx4 v102, s[40:43], s69 offen offset:2048 lds
    s_add_u32 m0, s79, 2048
    s_add_u32 s69, s74, 16384
    buffer_load_dwordx4 v100, s[36:39], s69 offen lds
    buffer_load_dwordx4 v101, s[36:39], s69 offen offset:1024 lds
    s_add_u32 m0, s61, 77824
    s_add_u32 s69, s75, 98304
    buffer_load_dwordx4 v102, s[40:43], s69 offen lds
    buffer_load_dwordx4 v102, s[40:43], s69 offen offset:1024 lds
    buffer_load_dwordx4 v102, s[40:43], s69 offen offset:2048 lds
    s_add_u32 s22, s20, 5373952
    s_addc_u32 s23, s21, 0
    s_load_dword s67, s[22:23], 0
    s_mov_b64 s[52:53], s[20:21]
    s_mov_b32 s54, 268435456
    s_mov_b32 s55, 0x20000
    s_mov_b64 s[48:49], s[16:17]
    s_mov_b32 s50, 4194304
    s_mov_b32 s51, 0x20000
    s_add_u32 m0, s79, 16384
    s_add_u32 s69, s74, 128
    buffer_load_dwordx4 v100, s[36:39], s69 offen lds
    buffer_load_dwordx4 v101, s[36:39], s69 offen offset:1024 lds
    s_add_u32 m0, s61, 90112
    s_add_u32 s69, s75, 196608
    buffer_load_dwordx4 v102, s[40:43], s69 offen lds
    buffer_load_dwordx4 v102, s[40:43], s69 offen offset:1024 lds
    buffer_load_dwordx4 v102, s[40:43], s69 offen offset:2048 lds
    s_add_u32 m0, s79, 18432
    s_add_u32 s69, s74, 16512
    buffer_load_dwordx4 v100, s[36:39], s69 offen lds
    buffer_load_dwordx4 v101, s[36:39], s69 offen offset:1024 lds
    s_add_u32 m0, s61, 102400
    s_add_u32 s69, s75, 294912
    buffer_load_dwordx4 v102, s[40:43], s69 offen lds
    buffer_load_dwordx4 v102, s[40:43], s69 offen offset:1024 lds
    buffer_load_dwordx4 v102, s[40:43], s69 offen offset:2048 lds
    s_and_b32 s73, s56, 1
    s_bfe_u32 s72, s56, 0x10001
    s_lshl_b32 s70, s73, 10
    s_lshl_b32 s71, s72, 12
    s_add_u32 s70, s70, s71
    s_add_u32 s70, s70, 151552
    v_add_u32 v103, s70, v127
    s_lshl_b32 s70, s73, 6
    s_lshl_b32 s71, s72, 8
    s_add_u32 s70, s70, s71
    s_add_u32 s70, s70, 159744
    v_lshl_add_u32 v104, v12, 2, s70
    v_lshlrev_b32 v106, 2, v12
    v_lshlrev_b32 v110, 2, v1
    v_and_b32 v111, 31, v1
    v_lshlrev_b32 v111, 4, v111
    v_mul_u32_u24 v8, 640, v7
    v_add_u32 v111, v111, v8
    v_mov_b32 v112, 0xffff0000
    v_mul_u32_u24 v8, 640, v6
    v_add_u32 v107, v8, v106
    s_mul_i32 s70, s63, 544
    s_add_u32 s70, s70, 160256
    v_and_b32 v9, 1, v6
    v_lshlrev_b32 v8, 5, v12
    v_lshl_add_u32 v8, v9, 4, v8
    v_lshl_add_u32 v8, v7, 3, v8
    v_add_u32 v108, s70, v8
    v_and_b32 v8, 1, v4
    v_bfe_u32 v10, v1, 3, 1
    v_lshlrev_b32 v11, 4, v8
    v_lshl_add_u32 v11, v10, 3, v11
    v_lshl_add_u32 v11, v5, 1, v11
    v_add_u32 v109, s70, v11
    s_lshl_b32 s70, s60, 2
    s_add_u32 s70, s70, s63
    s_mul_i32 s65, s70, 10240
    s_add_u32 s65, s65, 5505024
    s_mul_i32 s77, s59, 640
    s_add_u32 s77, s77, s65
    s_waitcnt lgkmcnt(0)
    s_add_u32 s67, s67, 1
    s_and_b32 s66, s67, 0xff
    s_mul_i32 s66, s66, 0x01010101
    s_xor_b32 s66, s66, 0x8e592b00
    s_mov_b32 s3, 0x10000
    v_and_b32 v8, 3, v1
    v_lshlrev_b32 v8, 3, v8
    v_lshrrev_b32_e64 v8, v8, s66
    v_mov_b32 v126, 0x00010001
    v_bfe_u32 v122, v8, 0, 2
    v_mul_u32_u24 v122, 0x8001, v122
    v_bfe_u32 v123, v8, 2, 2
    v_mul_u32_u24 v123, 0x8001, v123
    v_bfe_u32 v124, v8, 4, 2
    v_mul_u32_u24 v124, 0x8001, v124
    v_bfe_u32 v125, v8, 6, 2
    v_mul_u32_u24 v125, 0x8001, v125
    v_lshlrev_b32 v8, 1, v12
    v_lshrrev_b32_e64 v105, v8, s66
    s_mov_b32 s68, 1000000
    s_lshr_b32 s70, s59, 2
    s_add_u32 s70, s70, 1
    s_and_b32 s70, s70, 3
    s_mul_i32 s70, s70, 2560
    s_add_u32 s82, s70, s65
    s_lshr_b32 s70, s59, 2
    s_add_u32 s70, s70, 2
    s_and_b32 s70, s70, 3
    s_mul_i32 s70, s70, 2560
    s_add_u32 s83, s70, s65
    s_lshr_b32 s70, s59, 2
    s_add_u32 s70, s70, 3
    s_and_b32 s70, s70, 3
    s_mul_i32 s70, s70, 2560
    s_add_u32 s84, s70, s65
    s_lshr_b32 s70, s59, 2
    s_add_u32 s70, s70, 4
    s_and_b32 s70, s70, 3
    s_mul_i32 s70, s70, 2560
    s_add_u32 s85, s70, s65
    s_waitcnt vmcnt(13)
    s_barrier
    s_add_u32 m0, s79, 32768
    s_add_u32 s69, s74, 256
    buffer_load_dwordx4 v100, s[36:39], s69 offen lds
    buffer_load_dwordx4 v101, s[36:39], s69 offen offset:1024 lds
    s_add_u32 m0, s61, 114688
    s_add_u32 s69, s75, 393216
    buffer_load_dwordx4 v102, s[40:43], s69 offen lds
    buffer_load_dwordx4 v102, s[40:43], s69 offen offset:1024 lds
    buffer_load_dwordx4 v102, s[40:43], s69 offen offset:2048 lds
    s_add_u32 m0, s79, 34816
    s_add_u32 s69, s74, 16640
    buffer_load_dwordx4 v100, s[36:39], s69 offen lds
    buffer_load_dwordx4 v101, s[36:39], s69 offen offset:1024 lds
    s_add_u32 m0, s61, 126976
    s_add_u32 s69, s75, 491520
    buffer_load_dwordx4 v102, s[40:43], s69 offen lds
    buffer_load_dwordx4 v102, s[40:43], s69 offen offset:1024 lds
    buffer_load_dwordx4 v102, s[40:43], s69 offen offset:2048 lds
    s_waitcnt vmcnt(20)
    s_barrier
    s_add_u32 m0, s79, 49152
    s_add_u32 s69, s74, 384
    buffer_load_dwordx4 v100, s[36:39], s69 offen lds
    buffer_load_dwordx4 v101, s[36:39], s69 offen offset:1024 lds
    s_add_u32 m0, s61, 139264
    s_add_u32 s69, s75, 589824
    buffer_load_dwordx4 v102, s[40:43], s69 offen lds
    buffer_load_dwordx4 v102, s[40:43], s69 offen offset:1024 lds
    buffer_load_dwordx4 v102, s[40:43], s69 offen offset:2048 lds
    s_add_u32 m0, s79, 51200
    s_add_u32 s69, s74, 16768
    buffer_load_dwordx4 v100, s[36:39], s69 offen lds
    buffer_load_dwordx4 v101, s[36:39], s69 offen offset:1024 lds
    s_add_u32 m0, s61, 65536
    s_add_u32 s69, s75, 688128
    buffer_load_dwordx4 v102, s[40:43], s69 offen lds
    buffer_load_dwordx4 v102, s[40:43], s69 offen offset:1024 lds
    buffer_load_dwordx4 v102, s[40:43], s69 offen offset:2048 lds
    s_waitcnt vmcnt(23)
    s_barrier
    s_add_u32 m0, s79, 0
    s_add_u32 s69, s74, 512
    buffer_load_dwordx4 v100, s[36:39], s69 offen lds
    buffer_load_dwordx4 v101, s[36:39], s69 offen offset:1024 lds
    s_add_u32 m0, s61, 77824
    s_add_u32 s69, s75, 786432
    buffer_load_dwordx4 v102, s[40:43], s69 offen lds
    buffer_load_dwordx4 v102, s[40:43], s69 offen offset:1024 lds
    buffer_load_dwordx4 v102, s[40:43], s69 offen offset:2048 lds
    s_waitcnt vmcnt(25)
    s_barrier
    s_add_u32 m0, s79, 2048
    s_add_u32 s69, s74, 16896
    buffer_load_dwordx4 v100, s[36:39], s69 offen lds
    buffer_load_dwordx4 v101, s[36:39], s69 offen offset:1024 lds
    s_add_u32 m0, s61, 90112
    s_add_u32 s69, s75, 884736
    buffer_load_dwordx4 v102, s[40:43], s69 offen lds
    buffer_load_dwordx4 v102, s[40:43], s69 offen offset:1024 lds
    buffer_load_dwordx4 v102, s[40:43], s69 offen offset:2048 lds
    s_waitcnt vmcnt(23)
    s_barrier
    s_add_u32 m0, s79, 16384
    s_add_u32 s69, s74, 640
    buffer_load_dwordx4 v100, s[36:39], s69 offen lds
    buffer_load_dwordx4 v101, s[36:39], s69 offen offset:1024 lds
    s_add_u32 m0, s61, 102400
    s_add_u32 s69, s75, 983040
    buffer_load_dwordx4 v102, s[40:43], s69 offen lds
    buffer_load_dwordx4 v102, s[40:43], s69 offen offset:1024 lds
    buffer_load_dwordx4 v102, s[40:43], s69 offen offset:2048 lds
    s_waitcnt vmcnt(25)
    s_barrier
    s_add_u32 m0, s79, 18432
    s_add_u32 s69, s74, 17024
    buffer_load_dwordx4 v100, s[36:39], s69 offen lds
    buffer_load_dwordx4 v101, s[36:39], s69 offen offset:1024 lds
    s_add_u32 m0, s61, 114688
    s_add_u32 s69, s75, 1081344
    buffer_load_dwordx4 v102, s[40:43], s69 offen lds
    buffer_load_dwordx4 v102, s[40:43], s69 offen offset:1024 lds
    buffer_load_dwordx4 v102, s[40:43], s69 offen offset:2048 lds
    s_waitcnt vmcnt(23)
    s_barrier
    s_add_u32 m0, s79, 32768
    s_add_u32 s69, s74, 768
    buffer_load_dwordx4 v100, s[36:39], s69 offen lds
    buffer_load_dwordx4 v101, s[36:39], s69 offen offset:1024 lds
    s_add_u32 m0, s61, 126976
    s_add_u32 s69, s75, 1179648
    buffer_load_dwordx4 v102, s[40:43], s69 offen lds
    buffer_load_dwordx4 v102, s[40:43], s69 offen offset:1024 lds
    buffer_load_dwordx4 v102, s[40:43], s69 offen offset:2048 lds
    s_waitcnt vmcnt(25)
    s_barrier
    s_add_u32 m0, s79, 34816
    s_add_u32 s69, s74, 17152
    buffer_load_dwordx4 v100, s[36:39], s69 offen lds
    buffer_load_dwordx4 v101, s[36:39], s69 offen offset:1024 lds
    s_add_u32 m0, s61, 139264
    s_add_u32 s69, s75, 1277952
    buffer_load_dwordx4 v102, s[40:43], s69 offen lds
    buffer_load_dwordx4 v102, s[40:43], s69 offen offset:1024 lds
    buffer_load_dwordx4 v102, s[40:43], s69 offen offset:2048 lds
    s_waitcnt vmcnt(23)
    s_barrier
    s_add_u32 m0, s79, 49152
    s_add_u32 s69, s74, 896
    buffer_load_dwordx4 v100, s[36:39], s69 offen lds
    buffer_load_dwordx4 v101, s[36:39], s69 offen offset:1024 lds
    s_add_u32 m0, s61, 65536
    s_add_u32 s69, s75, 1376256
    buffer_load_dwordx4 v102, s[40:43], s69 offen lds
    buffer_load_dwordx4 v102, s[40:43], s69 offen offset:1024 lds
    buffer_load_dwordx4 v102, s[40:43], s69 offen offset:2048 lds
    s_waitcnt vmcnt(25)
    s_barrier
    s_add_u32 m0, s79, 51200
    s_add_u32 s69, s74, 17280
    buffer_load_dwordx4 v100, s[36:39], s69 offen lds
    buffer_load_dwordx4 v101, s[36:39], s69 offen offset:1024 lds
    s_add_u32 m0, s61, 77824
    s_add_u32 s69, s75, 1474560
    buffer_load_dwordx4 v102, s[40:43], s69 offen lds
    buffer_load_dwordx4 v102, s[40:43], s69 offen offset:1024 lds
    buffer_load_dwordx4 v102, s[40:43], s69 offen offset:2048 lds
    s_waitcnt vmcnt(23)
    s_barrier
    s_waitcnt vmcnt(20)
    s_barrier
    s_waitcnt vmcnt(13)
    s_barrier
    s_waitcnt vmcnt(10)
    s_barrier
    s_waitcnt vmcnt(3)
    s_barrier
    s_waitcnt vmcnt(0)
    s_barrier
    s_setprio 3
    s_barrier
    ds_read_b128 v[4:7], v103
    ds_read_b128 v[8:11], v103 offset:2048
    ds_read_b32 v20, v104
    ds_read_b32 v21, v104 offset:128
    s_waitcnt lgkmcnt(2)
    v_pk_add_f32 v[4:5], v[4:5], v[8:9]
    v_pk_add_f32 v[6:7], v[6:7], v[10:11]
    v_cvt_pk_bf16_f32 v8, v4, v5
    v_cvt_pk_bf16_f32 v9, v6, v7
    s_waitcnt lgkmcnt(0)
    v_add_f32 v20, v20, v21
    v_permlane32_swap_b32 v8, v10
    v_permlane32_swap_b32 v9, v11
    v_bfi_b32 v20, 3, v105, v20
    v_bfi_b32 v8, v126, v122, v8
    v_bfi_b32 v9, v126, v123, v9
    v_bfi_b32 v10, v126, v124, v10
    v_bfi_b32 v11, v126, v125, v11
    s_mov_b32 exec_hi, 0
    buffer_store_dwordx4 v[8:11], v127, s[52:55], s77 offen sc0 sc1
    buffer_store_dword v20, v110, s[52:55], s77 offen offset:512 sc0 sc1
    s_mov_b64 exec, -1
    s_setprio 0
    s_sleep 20
    s_setprio 3
    s_mov_b32 s58, 0
    s_mov_b32 s69, s82
    buffer_load_dwordx4 v[36:39], v111, s[52:55], s69 offen offset:0 sc0 sc1
    buffer_load_dwordx4 v[40:43], v111, s[52:55], s69 offen offset:1280 sc0 sc1
    buffer_load_dword v92, v107, s[52:55], s69 offen offset:512 sc0 sc1
    s_mov_b32 s69, s83
    buffer_load_dwordx4 v[52:55], v111, s[52:55], s69 offen offset:0 sc0 sc1
    buffer_load_dwordx4 v[56:59], v111, s[52:55], s69 offen offset:1280 sc0 sc1
    buffer_load_dword v93, v107, s[52:55], s69 offen offset:512 sc0 sc1
    s_mov_b32 s69, s84
    buffer_load_dwordx4 v[68:71], v111, s[52:55], s69 offen offset:0 sc0 sc1
    buffer_load_dwordx4 v[72:75], v111, s[52:55], s69 offen offset:1280 sc0 sc1
    buffer_load_dword v94, v107, s[52:55], s69 offen offset:512 sc0 sc1
    s_mov_b32 s69, s85
    buffer_load_dwordx4 v[84:87], v111, s[52:55], s69 offen offset:0 sc0 sc1
    buffer_load_dwordx4 v[88:91], v111, s[52:55], s69 offen offset:1280 sc0 sc1
    buffer_load_dword v95, v107, s[52:55], s69 offen offset:512 sc0 sc1
    s_waitcnt vmcnt(11)
    v_xor_b32 v4, v36, v122
    v_bfi_b32 v36, v126, s3, v36
    v_lshlrev_b32 v28, 16, v36
    v_and_b32 v29, v112, v36
    v_bitop3_b32 v4, v4, v37, v123 bitop3:0xf6
    v_bfi_b32 v37, v126, s3, v37
    v_lshlrev_b32 v30, 16, v37
    v_and_b32 v31, v112, v37
    v_bitop3_b32 v4, v4, v38, v124 bitop3:0xf6
    v_bfi_b32 v38, v126, s3, v38
    v_lshlrev_b32 v32, 16, v38
    v_and_b32 v33, v112, v38
    v_bitop3_b32 v4, v4, v39, v125 bitop3:0xf6
    v_bfi_b32 v39, v126, s3, v39
    v_lshlrev_b32 v34, 16, v39
    v_and_b32 v35, v112, v39
    s_waitcnt vmcnt(10)
    v_bitop3_b32 v4, v4, v40, v122 bitop3:0xf6
    v_bfi_b32 v40, v126, s3, v40
    v_lshlrev_b32 v8, 16, v40
    v_and_b32 v9, v112, v40
    v_pk_add_f32 v[28:29], v[28:29], v[8:9]
    v_bitop3_b32 v4, v4, v41, v123 bitop3:0xf6
    v_bfi_b32 v41, v126, s3, v41
    v_lshlrev_b32 v10, 16, v41
    v_and_b32 v11, v112, v41
    v_pk_add_f32 v[30:31], v[30:31], v[10:11]
    v_bitop3_b32 v4, v4, v42, v124 bitop3:0xf6
    v_bfi_b32 v42, v126, s3, v42
    v_lshlrev_b32 v12, 16, v42
    v_and_b32 v13, v112, v42
    v_pk_add_f32 v[32:33], v[32:33], v[12:13]
    v_bitop3_b32 v4, v4, v43, v125 bitop3:0xf6
    v_bfi_b32 v43, v126, s3, v43
    v_lshlrev_b32 v14, 16, v43
    v_and_b32 v15, v112, v43
    v_pk_add_f32 v[34:35], v[34:35], v[14:15]
    s_waitcnt vmcnt(9)
    v_and_b32 v4, v126, v4
    v_xor_b32 v5, v92, v105
    v_and_or_b32 v4, v5, 3, v4
    v_cmp_ne_u32 vcc, 0, v4
    v_and_b32 v92, -4, v92
    s_nop 0
    s_cmp_lg_u64 vcc, 0
    s_cselect_b32 s70, 1, 0
    s_or_b32 s58, s58, s70
    s_waitcnt vmcnt(8)
    v_xor_b32 v4, v52, v122
    v_bfi_b32 v52, v126, s3, v52
    v_lshlrev_b32 v44, 16, v52
    v_and_b32 v45, v112, v52
    v_bitop3_b32 v4, v4, v53, v123 bitop3:0xf6
    v_bfi_b32 v53, v126, s3, v53
    v_lshlrev_b32 v46, 16, v53
    v_and_b32 v47, v112, v53
    v_bitop3_b32 v4, v4, v54, v124 bitop3:0xf6
    v_bfi_b32 v54, v126, s3, v54
    v_lshlrev_b32 v48, 16, v54
    v_and_b32 v49, v112, v54
    v_bitop3_b32 v4, v4, v55, v125 bitop3:0xf6
    v_bfi_b32 v55, v126, s3, v55
    v_lshlrev_b32 v50, 16, v55
    v_and_b32 v51, v112, v55
    s_waitcnt vmcnt(7)
    v_bitop3_b32 v4, v4, v56, v122 bitop3:0xf6
    v_bfi_b32 v56, v126, s3, v56
    v_lshlrev_b32 v8, 16, v56
    v_and_b32 v9, v112, v56
    v_pk_add_f32 v[44:45], v[44:45], v[8:9]
    v_bitop3_b32 v4, v4, v57, v123 bitop3:0xf6
    v_bfi_b32 v57, v126, s3, v57
    v_lshlrev_b32 v10, 16, v57
    v_and_b32 v11, v112, v57
    v_pk_add_f32 v[46:47], v[46:47], v[10:11]
    v_bitop3_b32 v4, v4, v58, v124 bitop3:0xf6
    v_bfi_b32 v58, v126, s3, v58
    v_lshlrev_b32 v12, 16, v58
    v_and_b32 v13, v112, v58
    v_pk_add_f32 v[48:49], v[48:49], v[12:13]
    v_bitop3_b32 v4, v4, v59, v125 bitop3:0xf6
    v_bfi_b32 v59, v126, s3, v59
    v_lshlrev_b32 v14, 16, v59
    v_and_b32 v15, v112, v59
    v_pk_add_f32 v[50:51], v[50:51], v[14:15]
    s_waitcnt vmcnt(6)
    v_and_b32 v4, v126, v4
    v_xor_b32 v5, v93, v105
    v_and_or_b32 v4, v5, 3, v4
    v_cmp_ne_u32 vcc, 0, v4
    v_and_b32 v93, -4, v93
    s_nop 0
    s_cmp_lg_u64 vcc, 0
    s_cselect_b32 s70, 2, 0
    s_or_b32 s58, s58, s70
    s_waitcnt vmcnt(5)
    v_xor_b32 v4, v68, v122
    v_bfi_b32 v68, v126, s3, v68
    v_lshlrev_b32 v60, 16, v68
    v_and_b32 v61, v112, v68
    v_bitop3_b32 v4, v4, v69, v123 bitop3:0xf6
    v_bfi_b32 v69, v126, s3, v69
    v_lshlrev_b32 v62, 16, v69
    v_and_b32 v63, v112, v69
    v_bitop3_b32 v4, v4, v70, v124 bitop3:0xf6
    v_bfi_b32 v70, v126, s3, v70
    v_lshlrev_b32 v64, 16, v70
    v_and_b32 v65, v112, v70
    v_bitop3_b32 v4, v4, v71, v125 bitop3:0xf6
    v_bfi_b32 v71, v126, s3, v71
    v_lshlrev_b32 v66, 16, v71
    v_and_b32 v67, v112, v71
    s_waitcnt vmcnt(4)
    v_bitop3_b32 v4, v4, v72, v122 bitop3:0xf6
    v_bfi_b32 v72, v126, s3, v72
    v_lshlrev_b32 v8, 16, v72
    v_and_b32 v9, v112, v72
    v_pk_add_f32 v[60:61], v[60:61], v[8:9]
    v_bitop3_b32 v4, v4, v73, v123 bitop3:0xf6
    v_bfi_b32 v73, v126, s3, v73
    v_lshlrev_b32 v10, 16, v73
    v_and_b32 v11, v112, v73
    v_pk_add_f32 v[62:63], v[62:63], v[10:11]
    v_bitop3_b32 v4, v4, v74, v124 bitop3:0xf6
    v_bfi_b32 v74, v126, s3, v74
    v_lshlrev_b32 v12, 16, v74
    v_and_b32 v13, v112, v74
    v_pk_add_f32 v[64:65], v[64:65], v[12:13]
    v_bitop3_b32 v4, v4, v75, v125 bitop3:0xf6
    v_bfi_b32 v75, v126, s3, v75
    v_lshlrev_b32 v14, 16, v75
    v_and_b32 v15, v112, v75
    v_pk_add_f32 v[66:67], v[66:67], v[14:15]
    s_waitcnt vmcnt(3)
    v_and_b32 v4, v126, v4
    v_xor_b32 v5, v94, v105
    v_and_or_b32 v4, v5, 3, v4
    v_cmp_ne_u32 vcc, 0, v4
    v_and_b32 v94, -4, v94
    s_nop 0
    s_cmp_lg_u64 vcc, 0
    s_cselect_b32 s70, 4, 0
    s_or_b32 s58, s58, s70
    s_waitcnt vmcnt(2)
    v_xor_b32 v4, v84, v122
    v_bfi_b32 v84, v126, s3, v84
    v_lshlrev_b32 v76, 16, v84
    v_and_b32 v77, v112, v84
    v_bitop3_b32 v4, v4, v85, v123 bitop3:0xf6
    v_bfi_b32 v85, v126, s3, v85
    v_lshlrev_b32 v78, 16, v85
    v_and_b32 v79, v112, v85
    v_bitop3_b32 v4, v4, v86, v124 bitop3:0xf6
    v_bfi_b32 v86, v126, s3, v86
    v_lshlrev_b32 v80, 16, v86
    v_and_b32 v81, v112, v86
    v_bitop3_b32 v4, v4, v87, v125 bitop3:0xf6
    v_bfi_b32 v87, v126, s3, v87
    v_lshlrev_b32 v82, 16, v87
    v_and_b32 v83, v112, v87
    s_waitcnt vmcnt(1)
    v_bitop3_b32 v4, v4, v88, v122 bitop3:0xf6
    v_bfi_b32 v88, v126, s3, v88
    v_lshlrev_b32 v8, 16, v88
    v_and_b32 v9, v112, v88
    v_pk_add_f32 v[76:77], v[76:77], v[8:9]
    v_bitop3_b32 v4, v4, v89, v123 bitop3:0xf6
    v_bfi_b32 v89, v126, s3, v89
    v_lshlrev_b32 v10, 16, v89
    v_and_b32 v11, v112, v89
    v_pk_add_f32 v[78:79], v[78:79], v[10:11]
    v_bitop3_b32 v4, v4, v90, v124 bitop3:0xf6
    v_bfi_b32 v90, v126, s3, v90
    v_lshlrev_b32 v12, 16, v90
    v_and_b32 v13, v112, v90
    v_pk_add_f32 v[80:81], v[80:81], v[12:13]
    v_bitop3_b32 v4, v4, v91, v125 bitop3:0xf6
    v_bfi_b32 v91, v126, s3, v91
    v_lshlrev_b32 v14, 16, v91
    v_and_b32 v15, v112, v91
    v_pk_add_f32 v[82:83], v[82:83], v[14:15]
    s_waitcnt vmcnt(0)
    v_and_b32 v4, v126, v4
    v_xor_b32 v5, v95, v105
    v_and_or_b32 v4, v5, 3, v4
    v_cmp_ne_u32 vcc, 0, v4
    v_and_b32 v95, -4, v95
    s_nop 0
    s_cmp_lg_u64 vcc, 0
    s_cselect_b32 s70, 8, 0
    s_or_b32 s58, s58, s70
    s_cmp_lg_u32 s58, 0
    s_cbranch_scc1 Lgr_2
Lgk_3:
    v_pk_add_f32 v[28:29], v[28:29], v[44:45]
    v_pk_add_f32 v[30:31], v[30:31], v[46:47]
    v_pk_add_f32 v[32:33], v[32:33], v[48:49]
    v_pk_add_f32 v[34:35], v[34:35], v[50:51]
    v_pk_add_f32 v[60:61], v[60:61], v[76:77]
    v_pk_add_f32 v[62:63], v[62:63], v[78:79]
    v_pk_add_f32 v[64:65], v[64:65], v[80:81]
    v_pk_add_f32 v[66:67], v[66:67], v[82:83]
    v_pk_add_f32 v[28:29], v[28:29], v[60:61]
    v_pk_add_f32 v[30:31], v[30:31], v[62:63]
    v_pk_add_f32 v[32:33], v[32:33], v[64:65]
    v_pk_add_f32 v[34:35], v[34:35], v[66:67]
    s_nop 0
    v_permlane32_swap_b32 v28, v32
    v_permlane32_swap_b32 v29, v33
    v_permlane32_swap_b32 v30, v34
    v_permlane32_swap_b32 v31, v35
    v_pk_add_f32 v[28:29], v[28:29], v[32:33]
    v_pk_add_f32 v[30:31], v[30:31], v[34:35]
    v_cvt_pk_bf16_f32 v28, v28, v29
    v_cvt_pk_bf16_f32 v29, v30, v31
    ds_write_b64 v108, v[28:29]
    v_pk_add_f32 v[92:93], v[92:93], v[94:95]
    v_add_f32 v8, v92, v93
    v_mov_b32 v9, v8
    s_nop 1
    v_permlane16_swap_b32 v8, v9
    v_add_f32 v8, v8, v9
    v_mov_b32 v9, v8
    s_nop 1
    v_permlane32_swap_b32 v8, v9
    v_add_f32 v8, v8, v9
    v_cvt_pk_bf16_f32 v8, v8, v8
    ds_write_b16 v109, v8 offset:512
    s_waitcnt lgkmcnt(0)
    s_barrier
    s_setprio 0
    s_lshl_b32 s79, s63, 12
    s_mul_i32 s73, s64, 37120
    s_add_u32 s73, s73, s79
    s_add_u32 s73, s73, 6291456
    s_sleep 36
    s_add_u32 m0, s79, 98304
    s_add_u32 s69, s73, 0
    buffer_load_dwordx4 v127, s[52:55], s69 offen sc0 sc1 lds
    buffer_load_dwordx4 v127, s[52:55], s69 offen offset:1024 sc0 sc1 lds
    buffer_load_dwordx4 v127, s[52:55], s69 offen offset:2048 sc0 sc1 lds
    buffer_load_dwordx4 v127, s[52:55], s69 offen offset:3072 sc0 sc1 lds
    s_add_u32 m0, s79, 114688
    s_add_u32 s69, s73, 16384
    buffer_load_dwordx4 v127, s[52:55], s69 offen sc0 sc1 lds
    buffer_load_dwordx4 v127, s[52:55], s69 offen offset:1024 sc0 sc1 lds
    buffer_load_dwordx4 v127, s[52:55], s69 offen offset:2048 sc0 sc1 lds
    buffer_load_dwordx4 v127, s[52:55], s69 offen offset:3072 sc0 sc1 lds
    s_waitcnt vmcnt(4)
    s_branch L_fload
Lgr_2:
    s_cmp_eq_u32 s68, 0
    s_cbranch_scc1 Lgk_3
    s_sub_u32 s68, s68, 1
    s_sleep 6
    s_mov_b32 s57, s58
    s_mov_b32 s58, 0
    s_bitcmp1_b32 s57, 0
    s_cbranch_scc0 Lgi_4
    s_mov_b32 s69, s82
    buffer_load_dwordx4 v[36:39], v111, s[52:55], s69 offen offset:0 sc0 sc1
    buffer_load_dwordx4 v[40:43], v111, s[52:55], s69 offen offset:1280 sc0 sc1
    buffer_load_dword v92, v107, s[52:55], s69 offen offset:512 sc0 sc1
Lgi_4:
    s_bitcmp1_b32 s57, 1
    s_cbranch_scc0 Lgi_5
    s_mov_b32 s69, s83
    buffer_load_dwordx4 v[52:55], v111, s[52:55], s69 offen offset:0 sc0 sc1
    buffer_load_dwordx4 v[56:59], v111, s[52:55], s69 offen offset:1280 sc0 sc1
    buffer_load_dword v93, v107, s[52:55], s69 offen offset:512 sc0 sc1
Lgi_5:
    s_bitcmp1_b32 s57, 2
    s_cbranch_scc0 Lgi_6
    s_mov_b32 s69, s84
    buffer_load_dwordx4 v[68:71], v111, s[52:55], s69 offen offset:0 sc0 sc1
    buffer_load_dwordx4 v[72:75], v111, s[52:55], s69 offen offset:1280 sc0 sc1
    buffer_load_dword v94, v107, s[52:55], s69 offen offset:512 sc0 sc1
Lgi_6:
    s_bitcmp1_b32 s57, 3
    s_cbranch_scc0 Lgi_7
    s_mov_b32 s69, s85
    buffer_load_dwordx4 v[84:87], v111, s[52:55], s69 offen offset:0 sc0 sc1
    buffer_load_dwordx4 v[88:91], v111, s[52:55], s69 offen offset:1280 sc0 sc1
    buffer_load_dword v95, v107, s[52:55], s69 offen offset:512 sc0 sc1
Lgi_7:
    s_waitcnt vmcnt(0)
    s_bitcmp1_b32 s57, 0
    s_cbranch_scc0 Lgj_8
    v_xor_b32 v4, v36, v122
    v_bfi_b32 v36, v126, s3, v36
    v_lshlrev_b32 v28, 16, v36
    v_and_b32 v29, v112, v36
    v_bitop3_b32 v4, v4, v37, v123 bitop3:0xf6
    v_bfi_b32 v37, v126, s3, v37
    v_lshlrev_b32 v30, 16, v37
    v_and_b32 v31, v112, v37
    v_bitop3_b32 v4, v4, v38, v124 bitop3:0xf6
    v_bfi_b32 v38, v126, s3, v38
    v_lshlrev_b32 v32, 16, v38
    v_and_b32 v33, v112, v38
    v_bitop3_b32 v4, v4, v39, v125 bitop3:0xf6
    v_bfi_b32 v39, v126, s3, v39
    v_lshlrev_b32 v34, 16, v39
    v_and_b32 v35, v112, v39
    v_bitop3_b32 v4, v4, v40, v122 bitop3:0xf6
    v_bfi_b32 v40, v126, s3, v40
    v_lshlrev_b32 v8, 16, v40
    v_and_b32 v9, v112, v40
    v_pk_add_f32 v[28:29], v[28:29], v[8:9]
    v_bitop3_b32 v4, v4, v41, v123 bitop3:0xf6
    v_bfi_b32 v41, v126, s3, v41
    v_lshlrev_b32 v10, 16, v41
    v_and_b32 v11, v112, v41
    v_pk_add_f32 v[30:31], v[30:31], v[10:11]
    v_bitop3_b32 v4, v4, v42, v124 bitop3:0xf6
    v_bfi_b32 v42, v126, s3, v42
    v_lshlrev_b32 v12, 16, v42
    v_and_b32 v13, v112, v42
    v_pk_add_f32 v[32:33], v[32:33], v[12:13]
    v_bitop3_b32 v4, v4, v43, v125 bitop3:0xf6
    v_bfi_b32 v43, v126, s3, v43
    v_lshlrev_b32 v14, 16, v43
    v_and_b32 v15, v112, v43
    v_pk_add_f32 v[34:35], v[34:35], v[14:15]
    v_and_b32 v4, v126, v4
    v_xor_b32 v5, v92, v105
    v_and_or_b32 v4, v5, 3, v4
    v_cmp_ne_u32 vcc, 0, v4
    v_and_b32 v92, -4, v92
    s_nop 0
    s_cmp_lg_u64 vcc, 0
    s_cselect_b32 s70, 1, 0
    s_or_b32 s58, s58, s70
Lgj_8:
    s_bitcmp1_b32 s57, 1
    s_cbranch_scc0 Lgj_9
    v_xor_b32 v4, v52, v122
    v_bfi_b32 v52, v126, s3, v52
    v_lshlrev_b32 v44, 16, v52
    v_and_b32 v45, v112, v52
    v_bitop3_b32 v4, v4, v53, v123 bitop3:0xf6
    v_bfi_b32 v53, v126, s3, v53
    v_lshlrev_b32 v46, 16, v53
    v_and_b32 v47, v112, v53
    v_bitop3_b32 v4, v4, v54, v124 bitop3:0xf6
    v_bfi_b32 v54, v126, s3, v54
    v_lshlrev_b32 v48, 16, v54
    v_and_b32 v49, v112, v54
    v_bitop3_b32 v4, v4, v55, v125 bitop3:0xf6
    v_bfi_b32 v55, v126, s3, v55
    v_lshlrev_b32 v50, 16, v55
    v_and_b32 v51, v112, v55
    v_bitop3_b32 v4, v4, v56, v122 bitop3:0xf6
    v_bfi_b32 v56, v126, s3, v56
    v_lshlrev_b32 v8, 16, v56
    v_and_b32 v9, v112, v56
    v_pk_add_f32 v[44:45], v[44:45], v[8:9]
    v_bitop3_b32 v4, v4, v57, v123 bitop3:0xf6
    v_bfi_b32 v57, v126, s3, v57
    v_lshlrev_b32 v10, 16, v57
    v_and_b32 v11, v112, v57
    v_pk_add_f32 v[46:47], v[46:47], v[10:11]
    v_bitop3_b32 v4, v4, v58, v124 bitop3:0xf6
    v_bfi_b32 v58, v126, s3, v58
    v_lshlrev_b32 v12, 16, v58
    v_and_b32 v13, v112, v58
    v_pk_add_f32 v[48:49], v[48:49], v[12:13]
    v_bitop3_b32 v4, v4, v59, v125 bitop3:0xf6
    v_bfi_b32 v59, v126, s3, v59
    v_lshlrev_b32 v14, 16, v59
    v_and_b32 v15, v112, v59
    v_pk_add_f32 v[50:51], v[50:51], v[14:15]
    v_and_b32 v4, v126, v4
    v_xor_b32 v5, v93, v105
    v_and_or_b32 v4, v5, 3, v4
    v_cmp_ne_u32 vcc, 0, v4
    v_and_b32 v93, -4, v93
    s_nop 0
    s_cmp_lg_u64 vcc, 0
    s_cselect_b32 s70, 2, 0
    s_or_b32 s58, s58, s70
Lgj_9:
    s_bitcmp1_b32 s57, 2
    s_cbranch_scc0 Lgj_10
    v_xor_b32 v4, v68, v122
    v_bfi_b32 v68, v126, s3, v68
    v_lshlrev_b32 v60, 16, v68
    v_and_b32 v61, v112, v68
    v_bitop3_b32 v4, v4, v69, v123 bitop3:0xf6
    v_bfi_b32 v69, v126, s3, v69
    v_lshlrev_b32 v62, 16, v69
    v_and_b32 v63, v112, v69
    v_bitop3_b32 v4, v4, v70, v124 bitop3:0xf6
    v_bfi_b32 v70, v126, s3, v70
    v_lshlrev_b32 v64, 16, v70
    v_and_b32 v65, v112, v70
    v_bitop3_b32 v4, v4, v71, v125 bitop3:0xf6
    v_bfi_b32 v71, v126, s3, v71
    v_lshlrev_b32 v66, 16, v71
    v_and_b32 v67, v112, v71
    v_bitop3_b32 v4, v4, v72, v122 bitop3:0xf6
    v_bfi_b32 v72, v126, s3, v72
    v_lshlrev_b32 v8, 16, v72
    v_and_b32 v9, v112, v72
    v_pk_add_f32 v[60:61], v[60:61], v[8:9]
    v_bitop3_b32 v4, v4, v73, v123 bitop3:0xf6
    v_bfi_b32 v73, v126, s3, v73
    v_lshlrev_b32 v10, 16, v73
    v_and_b32 v11, v112, v73
    v_pk_add_f32 v[62:63], v[62:63], v[10:11]
    v_bitop3_b32 v4, v4, v74, v124 bitop3:0xf6
    v_bfi_b32 v74, v126, s3, v74
    v_lshlrev_b32 v12, 16, v74
    v_and_b32 v13, v112, v74
    v_pk_add_f32 v[64:65], v[64:65], v[12:13]
    v_bitop3_b32 v4, v4, v75, v125 bitop3:0xf6
    v_bfi_b32 v75, v126, s3, v75
    v_lshlrev_b32 v14, 16, v75
    v_and_b32 v15, v112, v75
    v_pk_add_f32 v[66:67], v[66:67], v[14:15]
    v_and_b32 v4, v126, v4
    v_xor_b32 v5, v94, v105
    v_and_or_b32 v4, v5, 3, v4
    v_cmp_ne_u32 vcc, 0, v4
    v_and_b32 v94, -4, v94
    s_nop 0
    s_cmp_lg_u64 vcc, 0
    s_cselect_b32 s70, 4, 0
    s_or_b32 s58, s58, s70
Lgj_10:
    s_bitcmp1_b32 s57, 3
    s_cbranch_scc0 Lgj_11
    v_xor_b32 v4, v84, v122
    v_bfi_b32 v84, v126, s3, v84
    v_lshlrev_b32 v76, 16, v84
    v_and_b32 v77, v112, v84
    v_bitop3_b32 v4, v4, v85, v123 bitop3:0xf6
    v_bfi_b32 v85, v126, s3, v85
    v_lshlrev_b32 v78, 16, v85
    v_and_b32 v79, v112, v85
    v_bitop3_b32 v4, v4, v86, v124 bitop3:0xf6
    v_bfi_b32 v86, v126, s3, v86
    v_lshlrev_b32 v80, 16, v86
    v_and_b32 v81, v112, v86
    v_bitop3_b32 v4, v4, v87, v125 bitop3:0xf6
    v_bfi_b32 v87, v126, s3, v87
    v_lshlrev_b32 v82, 16, v87
    v_and_b32 v83, v112, v87
    v_bitop3_b32 v4, v4, v88, v122 bitop3:0xf6
    v_bfi_b32 v88, v126, s3, v88
    v_lshlrev_b32 v8, 16, v88
    v_and_b32 v9, v112, v88
    v_pk_add_f32 v[76:77], v[76:77], v[8:9]
    v_bitop3_b32 v4, v4, v89, v123 bitop3:0xf6
    v_bfi_b32 v89, v126, s3, v89
    v_lshlrev_b32 v10, 16, v89
    v_and_b32 v11, v112, v89
    v_pk_add_f32 v[78:79], v[78:79], v[10:11]
    v_bitop3_b32 v4, v4, v90, v124 bitop3:0xf6
    v_bfi_b32 v90, v126, s3, v90
    v_lshlrev_b32 v12, 16, v90
    v_and_b32 v13, v112, v90
    v_pk_add_f32 v[80:81], v[80:81], v[12:13]
    v_bitop3_b32 v4, v4, v91, v125 bitop3:0xf6
    v_bfi_b32 v91, v126, s3, v91
    v_lshlrev_b32 v14, 16, v91
    v_and_b32 v15, v112, v91
    v_pk_add_f32 v[82:83], v[82:83], v[14:15]
    v_and_b32 v4, v126, v4
    v_xor_b32 v5, v95, v105
    v_and_or_b32 v4, v5, 3, v4
    v_cmp_ne_u32 vcc, 0, v4
    v_and_b32 v95, -4, v95
    s_nop 0
    s_cmp_lg_u64 vcc, 0
    s_cselect_b32 s70, 8, 0
    s_or_b32 s58, s58, s70
Lgj_11:
    s_cmp_lg_u32 s58, 0
    s_cbranch_scc1 Lgr_2
    s_branch Lgk_3
L_bcomp:
    v_and_b32 v8, 31, v1
    v_bfe_u32 v11, v8, 1, 3
    v_xor_b32 v11, v11, v7
    v_lshlrev_b32 v9, 7, v8
    v_lshl_add_u32 v9, v11, 4, v9
    s_and_b32 s73, s56, 1
    s_lshr_b32 s88, s56, 1
    s_lshl_b32 s72, s73, 13
    v_add_u32 v108, s72, v9
    v_and_b32 v10, 3, v4
    v_mul_u32_u24 v9, 3072, v7
    v_lshl_add_u32 v9, v10, 7, v9
    v_lshrrev_b32 v10, 1, v10
    v_xor_b32 v10, s88, v10
    v_lshl_add_u32 v9, v10, 6, v9
    v_and_b32 v6, 1, v6
    v_lshl_add_u32 v9, v6, 5, v9
    v_lshl_add_u32 v9, v5, 3, v9
    v_add_u32 v110, 65536, v9
    v_lshl_add_u32 v9, v7, 4, v12
    v_lshlrev_b32 v9, 4, v9
    v_lshl_add_u32 v9, v6, 10, v9
    s_lshl_b32 s70, s88, 1
    s_add_u32 s70, s70, s73
    s_lshl_b32 s71, s70, 11
    s_add_u32 s71, s71, 151552
    v_add_u32 v111, s71, v9
    s_lshl_b32 s71, s70, 7
    s_add_u32 s71, s71, 159744
    v_lshl_add_u32 v112, v8, 2, s71
    v_and_b32 v8, 1, v4
    v_bfe_u32 v10, v1, 3, 1
    v_lshlrev_b32 v8, 3, v8
    v_lshl_add_u32 v8, v10, 2, v8
    v_add_u32 v8, v8, v5
    v_lshlrev_b32 v8, 5, v8
    v_cmp_eq_u32 vcc, 1, v6
    v_mov_b32 v10, 512
    s_nop 0
    v_cndmask_b32 v8, v8, v10, vcc
    v_lshl_add_u32 v8, v7, 4, v8
    s_mul_i32 s70, s88, 1088
    s_add_u32 s70, s70, 160256
    v_add_u32 v115, s70, v8
    s_mov_b32 s80, 0x3fb8aa3b
    s_mov_b32 s81, 0x3fb8aa3b
    s_mov_b32 s90, 0x358637bd
    s_mov_b32 s91, 0x358637bd
    s_mov_b32 s86, 0xffff
    s_mov_b32 s87, 0xffff
    s_lshl_b32 s78, s59, 1
    s_add_u32 s78, s78, s73
    s_mul_i32 s78, s78, 74240
    s_lshl_b32 s70, s60, 1
    s_add_u32 s70, s70, s88
    s_lshl_b32 s70, s70, 11
    s_add_u32 s78, s78, s70
    s_add_u32 s78, s78, 6291456
    s_add_u32 s77, s78, 37120
    s_waitcnt lgkmcnt(0)
    s_add_u32 s22, s20, 5373952
    s_addc_u32 s23, s21, 0
    s_load_dword s67, s[22:23], 0
    s_mov_b64 s[52:53], s[20:21]
    s_mov_b32 s54, 268435456
    s_mov_b32 s55, 0x20000
    s_mov_b64 s[48:49], s[16:17]
    s_mov_b32 s50, 4194304
    s_mov_b32 s51, 0x20000
    v_mov_b32 v116, 0x3f803f80
    v_mov_b32 v117, 0x3f803f80
    v_mov_b32 v118, 0x3f803f80
    v_mov_b32 v119, 0x3f803f80
    v_mov_b32 v4, s90
    v_mov_b32 v5, s90
    v_mov_b32 v6, s90
    v_mov_b32 v7, s90
    v_mov_b32 v8, s90
    v_mov_b32 v9, s90
    v_mov_b32 v10, s90
    v_mov_b32 v11, s90
    v_mov_b32 v12, s90
    v_mov_b32 v13, s90
    v_mov_b32 v14, s90
    v_mov_b32 v15, s90
    v_mov_b32 v16, s90
    v_mov_b32 v17, s90
    v_mov_b32 v18, s90
    v_mov_b32 v19, s90
    v_mov_b32 v20, s90
    v_mov_b32 v21, s90
    v_mov_b32 v22, s90
    v_mov_b32 v23, s90
    v_mov_b32 v24, s90
    v_mov_b32 v25, s90
    v_mov_b32 v26, s90
    v_mov_b32 v27, s90
    v_mov_b32 v28, s90
    v_mov_b32 v29, s90
    v_mov_b32 v30, s90
    v_mov_b32 v31, s90
    v_mov_b32 v32, s90
    v_mov_b32 v33, s90
    v_mov_b32 v34, s90
    v_mov_b32 v35, s90
    v_mov_b32 v68, s90
    v_mov_b32 v69, s90
    v_mov_b32 v70, s90
    v_mov_b32 v71, s90
    v_mov_b32 v72, s90
    v_mov_b32 v73, s90
    v_mov_b32 v74, s90
    v_mov_b32 v75, s90
    v_mov_b32 v76, s90
    v_mov_b32 v77, s90
    v_mov_b32 v78, s90
    v_mov_b32 v79, s90
    v_mov_b32 v80, s90
    v_mov_b32 v81, s90
    v_mov_b32 v82, s90
    v_mov_b32 v83, s90
    v_mov_b32 v84, s90
    v_mov_b32 v85, s90
    v_mov_b32 v86, s90
    v_mov_b32 v87, s90
    v_mov_b32 v88, s90
    v_mov_b32 v89, s90
    v_mov_b32 v90, s90
    v_mov_b32 v91, s90
    v_mov_b32 v92, s90
    v_mov_b32 v93, s90
    v_mov_b32 v94, s90
    v_mov_b32 v95, s90
    v_mov_b32 v96, s90
    v_mov_b32 v97, s90
    v_mov_b32 v98, s90
    v_mov_b32 v99, s90
    v_mov_b32 v120, 0xb5c1a2a0
    v_mov_b32 v121, 0xb5c1a2a0
    v_xor_b32 v100, 32, v108
    v_xor_b32 v101, 64, v108
    v_xor_b32 v102, 96, v108
    v_add_u32 v103, 49152, v110
    s_waitcnt vmcnt(0) lgkmcnt(0)
    s_add_u32 s67, s67, 1
    s_and_b32 s66, s67, 0xff
    s_mul_i32 s66, s66, 0x01010101
    s_xor_b32 s66, s66, 0x8e592b00
    s_mov_b32 s3, 0x10000
    v_and_b32 v104, 3, v1
    v_lshlrev_b32 v104, 3, v104
    v_lshrrev_b32_e64 v104, v104, s66
    v_mov_b32 v126, 0x00010001
    v_bfe_u32 v122, v104, 0, 2
    v_mul_u32_u24 v122, 0x8001, v122
    v_bfe_u32 v123, v104, 2, 2
    v_mul_u32_u24 v123, 0x8001, v123
    v_bfe_u32 v124, v104, 4, 2
    v_mul_u32_u24 v124, 0x8001, v124
    v_bfe_u32 v125, v104, 6, 2
    v_mul_u32_u24 v125, 0x8001, v125
    s_lshl_b32 s75, s89, 2
    s_add_u32 s75, s75, s63
    s_lshl_b32 s74, s75, 10
    s_mul_i32 s75, s75, 37120
    s_add_u32 s75, s75, 8912896
    v_and_b32 v104, 7, v1
    v_lshlrev_b32 v104, 7, v104
    s_add_u32 s65, s74, 5439488
    s_mov_b32 s68, 1000000
    s_lshl_b32 s62, s59, 3
    s_add_u32 s62, s62, s60
    s_lshl_b32 s62, s62, 2
    s_add_u32 s62, s62, s56
    v_lshlrev_b32 v107, 7, v1
    s_barrier
    ds_read_b128 a[0:3], v108 offset:0
    ds_read_b128 a[4:7], v108 offset:4096
    ds_read_b64_tr_b16 a[20:21], v110 offset:1024
    ds_read_b64_tr_b16 a[22:23], v110 offset:1536
    ds_read_b64_tr_b16 a[24:25], v110 offset:2048
    ds_read_b64_tr_b16 a[26:27], v110 offset:2560
    ds_read_b64_tr_b16 a[16:17], v110 offset:0
    ds_read_b64_tr_b16 a[18:19], v110 offset:512
    ds_read_b128 a[8:11], v100 offset:0
    ds_read_b128 a[12:15], v100 offset:4096
    ds_read_b64_tr_b16 a[32:33], v110 offset:7168
    ds_read_b64_tr_b16 a[34:35], v110 offset:7680
    ds_read_b64_tr_b16 a[36:37], v110 offset:8192
    ds_read_b64_tr_b16 a[38:39], v110 offset:8704
    ds_read_b64_tr_b16 a[28:29], v110 offset:6144
    ds_read_b64_tr_b16 a[30:31], v110 offset:6656
    s_waitcnt lgkmcnt(0)
    s_barrier
    ds_read_b128 a[40:43], v101 offset:0
    ds_read_b128 a[44:47], v101 offset:4096
    v_mfma_f32_32x32x16_bf16 v[4:19], a[0:3], a[20:23], v[4:19]
    ds_read_b64_tr_b16 a[60:61], v110 offset:13312
    ds_read_b64_tr_b16 a[62:63], v110 offset:13824
    ds_read_b64_tr_b16 a[64:65], v110 offset:14336
    v_mfma_f32_32x32x16_bf16 v[20:35], a[4:7], a[20:23], v[20:35]
    ds_read_b64_tr_b16 a[66:67], v110 offset:14848
    ds_read_b64_tr_b16 a[56:57], v110 offset:12288
    ds_read_b64_tr_b16 a[58:59], v110 offset:12800
    v_mfma_f32_32x32x16_bf16 v[36:51], a[0:3], a[24:27], 0
    ds_read_b128 a[48:51], v102 offset:0
    ds_read_b128 a[52:55], v102 offset:4096
    ds_read_b64_tr_b16 a[72:73], v110 offset:19456
    v_mfma_f32_32x32x16_bf16 v[52:67], a[4:7], a[24:27], 0
    ds_read_b64_tr_b16 a[74:75], v110 offset:19968
    ds_read_b64_tr_b16 a[76:77], v110 offset:20480
    ds_read_b64_tr_b16 a[78:79], v110 offset:20992
    v_mfma_f32_32x32x16_bf16 v[68:83], a[16:19], a[0:3], v[68:83]
    ds_read_b64_tr_b16 a[68:69], v110 offset:18432
    ds_read_b64_tr_b16 a[70:71], v110 offset:18944
    v_mfma_f32_32x32x16_bf16 v[84:99], a[16:19], a[4:7], v[84:99]
    v_mfma_f32_32x32x16_bf16 v[4:19], a[8:11], a[32:35], v[4:19]
    v_mfma_f32_32x32x16_bf16 v[20:35], a[12:15], a[32:35], v[20:35]
    v_mfma_f32_32x32x16_bf16 v[36:51], a[8:11], a[36:39], v[36:51]
    v_mfma_f32_32x32x16_bf16 v[52:67], a[12:15], a[36:39], v[52:67]
    v_mfma_f32_32x32x16_bf16 v[68:83], a[28:31], a[8:11], v[68:83]
    v_mfma_f32_32x32x16_bf16 v[84:99], a[28:31], a[12:15], v[84:99]
    s_waitcnt lgkmcnt(0)
    s_barrier
    ds_read_b128 a[0:3], v108 offset:16384
    ds_read_b128 a[4:7], v108 offset:20480
    v_mfma_f32_32x32x16_bf16 v[4:19], a[40:43], a[60:63], v[4:19]
    ds_read_b64_tr_b16 a[20:21], v110 offset:25600
    ds_read_b64_tr_b16 a[22:23], v110 offset:26112
    ds_read_b64_tr_b16 a[24:25], v110 offset:26624
    v_mfma_f32_32x32x16_bf16 v[20:35], a[44:47], a[60:63], v[20:35]
    ds_read_b64_tr_b16 a[26:27], v110 offset:27136
    ds_read_b64_tr_b16 a[16:17], v110 offset:24576
    ds_read_b64_tr_b16 a[18:19], v110 offset:25088
    v_mfma_f32_32x32x16_bf16 v[36:51], a[40:43], a[64:67], v[36:51]
    ds_read_b128 a[8:11], v100 offset:16384
    ds_read_b128 a[12:15], v100 offset:20480
    ds_read_b64_tr_b16 a[32:33], v110 offset:31744
    v_mfma_f32_32x32x16_bf16 v[52:67], a[44:47], a[64:67], v[52:67]
    ds_read_b64_tr_b16 a[34:35], v110 offset:32256
    ds_read_b64_tr_b16 a[36:37], v110 offset:32768
    ds_read_b64_tr_b16 a[38:39], v110 offset:33280
    v_mfma_f32_32x32x16_bf16 v[68:83], a[56:59], a[40:43], v[68:83]
    ds_read_b64_tr_b16 a[28:29], v110 offset:30720
    ds_read_b64_tr_b16 a[30:31], v110 offset:31232
    v_mfma_f32_32x32x16_bf16 v[84:99], a[56:59], a[44:47], v[84:99]
    v_mfma_f32_32x32x16_bf16 v[4:19], a[48:51], a[72:75], v[4:19]
    v_mfma_f32_32x32x16_bf16 v[20:35], a[52:55], a[72:75], v[20:35]
    v_mfma_f32_32x32x16_bf16 v[36:51], a[48:51], a[76:79], v[36:51]
    v_mfma_f32_32x32x16_bf16 v[52:67], a[52:55], a[76:79], v[52:67]
    v_mfma_f32_32x32x16_bf16 v[68:83], a[68:71], a[48:51], v[68:83]
    v_mfma_f32_32x32x16_bf16 v[84:99], a[68:71], a[52:55], v[84:99]
    s_waitcnt lgkmcnt(0)
    s_barrier
    ds_read_b128 a[40:43], v101 offset:16384
    ds_read_b128 a[44:47], v101 offset:20480
    v_mfma_f32_32x32x16_bf16 v[4:19], a[0:3], a[20:23], v[4:19]
    ds_read_b64_tr_b16 a[60:61], v110 offset:37888
    ds_read_b64_tr_b16 a[62:63], v110 offset:38400
    ds_read_b64_tr_b16 a[64:65], v110 offset:38912
    v_mfma_f32_32x32x16_bf16 v[20:35], a[4:7], a[20:23], v[20:35]
    ds_read_b64_tr_b16 a[66:67], v110 offset:39424
    ds_read_b64_tr_b16 a[56:57], v110 offset:36864
    ds_read_b64_tr_b16 a[58:59], v110 offset:37376
    v_mfma_f32_32x32x16_bf16 v[36:51], a[0:3], a[24:27], v[36:51]
    ds_read_b128 a[48:51], v102 offset:16384
    ds_read_b128 a[52:55], v102 offset:20480
    ds_read_b64_tr_b16 a[72:73], v110 offset:44032
    v_mfma_f32_32x32x16_bf16 v[52:67], a[4:7], a[24:27], v[52:67]
    ds_read_b64_tr_b16 a[74:75], v110 offset:44544
    ds_read_b64_tr_b16 a[76:77], v110 offset:45056
    ds_read_b64_tr_b16 a[78:79], v110 offset:45568
    v_mfma_f32_32x32x16_bf16 v[68:83], a[16:19], a[0:3], v[68:83]
    ds_read_b64_tr_b16 a[68:69], v110 offset:43008
    ds_read_b64_tr_b16 a[70:71], v110 offset:43520
    v_mfma_f32_32x32x16_bf16 v[84:99], a[16:19], a[4:7], v[84:99]
    v_mfma_f32_32x32x16_bf16 v[4:19], a[8:11], a[32:35], v[4:19]
    v_mfma_f32_32x32x16_bf16 v[20:35], a[12:15], a[32:35], v[20:35]
    v_mfma_f32_32x32x16_bf16 v[36:51], a[8:11], a[36:39], v[36:51]
    v_mfma_f32_32x32x16_bf16 v[52:67], a[12:15], a[36:39], v[52:67]
    v_mfma_f32_32x32x16_bf16 v[68:83], a[28:31], a[8:11], v[68:83]
    v_mfma_f32_32x32x16_bf16 v[84:99], a[28:31], a[12:15], v[84:99]
    s_waitcnt lgkmcnt(0)
    s_barrier
    ds_read_b128 a[0:3], v108 offset:32768
    ds_read_b128 a[4:7], v108 offset:36864
    v_mfma_f32_32x32x16_bf16 v[4:19], a[40:43], a[60:63], v[4:19]
    ds_read_b64_tr_b16 a[20:21], v103 offset:1024
    ds_read_b64_tr_b16 a[22:23], v103 offset:1536
    ds_read_b64_tr_b16 a[24:25], v103 offset:2048
    v_mfma_f32_32x32x16_bf16 v[20:35], a[44:47], a[60:63], v[20:35]
    ds_read_b64_tr_b16 a[26:27], v103 offset:2560
    ds_read_b64_tr_b16 a[16:17], v103 offset:0
    ds_read_b64_tr_b16 a[18:19], v103 offset:512
    v_mfma_f32_32x32x16_bf16 v[36:51], a[40:43], a[64:67], v[36:51]
    ds_read_b128 a[8:11], v100 offset:32768
    ds_read_b128 a[12:15], v100 offset:36864
    ds_read_b64_tr_b16 a[32:33], v103 offset:7168
    v_mfma_f32_32x32x16_bf16 v[52:67], a[44:47], a[64:67], v[52:67]
    ds_read_b64_tr_b16 a[34:35], v103 offset:7680
    ds_read_b64_tr_b16 a[36:37], v103 offset:8192
    ds_read_b64_tr_b16 a[38:39], v103 offset:8704
    v_mfma_f32_32x32x16_bf16 v[68:83], a[56:59], a[40:43], v[68:83]
    ds_read_b64_tr_b16 a[28:29], v103 offset:6144
    ds_read_b64_tr_b16 a[30:31], v103 offset:6656
    v_mfma_f32_32x32x16_bf16 v[84:99], a[56:59], a[44:47], v[84:99]
    v_mfma_f32_32x32x16_bf16 v[4:19], a[48:51], a[72:75], v[4:19]
    v_mfma_f32_32x32x16_bf16 v[20:35], a[52:55], a[72:75], v[20:35]
    v_mfma_f32_32x32x16_bf16 v[36:51], a[48:51], a[76:79], v[36:51]
    v_mfma_f32_32x32x16_bf16 v[52:67], a[52:55], a[76:79], v[52:67]
    v_mfma_f32_32x32x16_bf16 v[68:83], a[68:71], a[48:51], v[68:83]
    v_mfma_f32_32x32x16_bf16 v[84:99], a[68:71], a[52:55], v[84:99]
    s_waitcnt lgkmcnt(0)
    s_barrier
    ds_read_b128 a[40:43], v101 offset:32768
    ds_read_b128 a[44:47], v101 offset:36864
    v_mfma_f32_32x32x16_bf16 v[4:19], a[0:3], a[20:23], v[4:19]
    ds_read_b64_tr_b16 a[60:61], v103 offset:13312
    ds_read_b64_tr_b16 a[62:63], v103 offset:13824
    ds_read_b64_tr_b16 a[64:65], v103 offset:14336
    v_mfma_f32_32x32x16_bf16 v[20:35], a[4:7], a[20:23], v[20:35]
    ds_read_b64_tr_b16 a[66:67], v103 offset:14848
    ds_read_b64_tr_b16 a[56:57], v103 offset:12288
    ds_read_b64_tr_b16 a[58:59], v103 offset:12800
    v_mfma_f32_32x32x16_bf16 v[36:51], a[0:3], a[24:27], v[36:51]
    ds_read_b128 a[48:51], v102 offset:32768
    ds_read_b128 a[52:55], v102 offset:36864
    ds_read_b64_tr_b16 a[72:73], v103 offset:19456
    v_mfma_f32_32x32x16_bf16 v[52:67], a[4:7], a[24:27], v[52:67]
    ds_read_b64_tr_b16 a[74:75], v103 offset:19968
    ds_read_b64_tr_b16 a[76:77], v103 offset:20480
    ds_read_b64_tr_b16 a[78:79], v103 offset:20992
    v_mfma_f32_32x32x16_bf16 v[68:83], a[16:19], a[0:3], v[68:83]
    ds_read_b64_tr_b16 a[68:69], v103 offset:18432
    ds_read_b64_tr_b16 a[70:71], v103 offset:18944
    v_mfma_f32_32x32x16_bf16 v[84:99], a[16:19], a[4:7], v[84:99]
    v_mfma_f32_32x32x16_bf16 v[4:19], a[8:11], a[32:35], v[4:19]
    v_mfma_f32_32x32x16_bf16 v[20:35], a[12:15], a[32:35], v[20:35]
    v_mfma_f32_32x32x16_bf16 v[36:51], a[8:11], a[36:39], v[36:51]
    v_mfma_f32_32x32x16_bf16 v[52:67], a[12:15], a[36:39], v[52:67]
    v_mfma_f32_32x32x16_bf16 v[68:83], a[28:31], a[8:11], v[68:83]
    v_mfma_f32_32x32x16_bf16 v[84:99], a[28:31], a[12:15], v[84:99]
    s_waitcnt lgkmcnt(0)
    s_barrier
    ds_read_b128 a[0:3], v108 offset:49152
    ds_read_b128 a[4:7], v108 offset:53248
    v_mfma_f32_32x32x16_bf16 v[4:19], a[40:43], a[60:63], v[4:19]
    ds_read_b64_tr_b16 a[20:21], v103 offset:25600
    ds_read_b64_tr_b16 a[22:23], v103 offset:26112
    ds_read_b64_tr_b16 a[24:25], v103 offset:26624
    v_mfma_f32_32x32x16_bf16 v[20:35], a[44:47], a[60:63], v[20:35]
    ds_read_b64_tr_b16 a[26:27], v103 offset:27136
    ds_read_b64_tr_b16 a[16:17], v103 offset:24576
    ds_read_b64_tr_b16 a[18:19], v103 offset:25088
    v_mfma_f32_32x32x16_bf16 v[36:51], a[40:43], a[64:67], v[36:51]
    ds_read_b128 a[8:11], v100 offset:49152
    ds_read_b128 a[12:15], v100 offset:53248
    ds_read_b64_tr_b16 a[32:33], v103 offset:31744
    v_mfma_f32_32x32x16_bf16 v[52:67], a[44:47], a[64:67], v[52:67]
    ds_read_b64_tr_b16 a[34:35], v103 offset:32256
    ds_read_b64_tr_b16 a[36:37], v103 offset:32768
    ds_read_b64_tr_b16 a[38:39], v103 offset:33280
    v_mfma_f32_32x32x16_bf16 v[68:83], a[56:59], a[40:43], v[68:83]
    ds_read_b64_tr_b16 a[28:29], v103 offset:30720
    ds_read_b64_tr_b16 a[30:31], v103 offset:31232
    v_mfma_f32_32x32x16_bf16 v[84:99], a[56:59], a[44:47], v[84:99]
    v_mfma_f32_32x32x16_bf16 v[4:19], a[48:51], a[72:75], v[4:19]
    v_mfma_f32_32x32x16_bf16 v[20:35], a[52:55], a[72:75], v[20:35]
    v_mfma_f32_32x32x16_bf16 v[36:51], a[48:51], a[76:79], v[36:51]
    v_mfma_f32_32x32x16_bf16 v[52:67], a[52:55], a[76:79], v[52:67]
    v_mfma_f32_32x32x16_bf16 v[68:83], a[68:71], a[48:51], v[68:83]
    v_mfma_f32_32x32x16_bf16 v[84:99], a[68:71], a[52:55], v[84:99]
    s_waitcnt lgkmcnt(0)
    s_barrier
    ds_read_b128 a[40:43], v101 offset:49152
    ds_read_b128 a[44:47], v101 offset:53248
    v_mfma_f32_32x32x16_bf16 v[4:19], a[0:3], a[20:23], v[4:19]
    ds_read_b64_tr_b16 a[60:61], v110 offset:1024
    ds_read_b64_tr_b16 a[62:63], v110 offset:1536
    ds_read_b64_tr_b16 a[64:65], v110 offset:2048
    v_mfma_f32_32x32x16_bf16 v[20:35], a[4:7], a[20:23], v[20:35]
    ds_read_b64_tr_b16 a[66:67], v110 offset:2560
    ds_read_b64_tr_b16 a[56:57], v110 offset:0
    ds_read_b64_tr_b16 a[58:59], v110 offset:512
    v_mfma_f32_32x32x16_bf16 v[36:51], a[0:3], a[24:27], v[36:51]
    ds_read_b128 a[48:51], v102 offset:49152
    ds_read_b128 a[52:55], v102 offset:53248
    ds_read_b64_tr_b16 a[72:73], v110 offset:7168
    v_mfma_f32_32x32x16_bf16 v[52:67], a[4:7], a[24:27], v[52:67]
    ds_read_b64_tr_b16 a[74:75], v110 offset:7680
    ds_read_b64_tr_b16 a[76:77], v110 offset:8192
    ds_read_b64_tr_b16 a[78:79], v110 offset:8704
    v_mfma_f32_32x32x16_bf16 v[68:83], a[16:19], a[0:3], v[68:83]
    ds_read_b64_tr_b16 a[68:69], v110 offset:6144
    ds_read_b64_tr_b16 a[70:71], v110 offset:6656
    v_mfma_f32_32x32x16_bf16 v[84:99], a[16:19], a[4:7], v[84:99]
    v_mfma_f32_32x32x16_bf16 v[4:19], a[8:11], a[32:35], v[4:19]
    v_mfma_f32_32x32x16_bf16 v[20:35], a[12:15], a[32:35], v[20:35]
    v_mfma_f32_32x32x16_bf16 v[36:51], a[8:11], a[36:39], v[36:51]
    v_mfma_f32_32x32x16_bf16 v[52:67], a[12:15], a[36:39], v[52:67]
    v_mfma_f32_32x32x16_bf16 v[68:83], a[28:31], a[8:11], v[68:83]
    v_mfma_f32_32x32x16_bf16 v[84:99], a[28:31], a[12:15], v[84:99]
    s_waitcnt lgkmcnt(0)
    s_barrier
    ds_read_b128 a[0:3], v108 offset:0
    ds_read_b128 a[4:7], v108 offset:4096
    v_mfma_f32_32x32x16_bf16 v[4:19], a[40:43], a[60:63], v[4:19]
    ds_read_b64_tr_b16 a[20:21], v110 offset:13312
    ds_read_b64_tr_b16 a[22:23], v110 offset:13824
    ds_read_b64_tr_b16 a[24:25], v110 offset:14336
    v_mfma_f32_32x32x16_bf16 v[20:35], a[44:47], a[60:63], v[20:35]
    ds_read_b64_tr_b16 a[26:27], v110 offset:14848
    ds_read_b64_tr_b16 a[16:17], v110 offset:12288
    ds_read_b64_tr_b16 a[18:19], v110 offset:12800
    v_mfma_f32_32x32x16_bf16 v[36:51], a[40:43], a[64:67], v[36:51]
    ds_read_b128 a[8:11], v100 offset:0
    ds_read_b128 a[12:15], v100 offset:4096
    ds_read_b64_tr_b16 a[32:33], v110 offset:19456
    v_mfma_f32_32x32x16_bf16 v[52:67], a[44:47], a[64:67], v[52:67]
    ds_read_b64_tr_b16 a[34:35], v110 offset:19968
    ds_read_b64_tr_b16 a[36:37], v110 offset:20480
    ds_read_b64_tr_b16 a[38:39], v110 offset:20992
    v_mfma_f32_32x32x16_bf16 v[68:83], a[56:59], a[40:43], v[68:83]
    ds_read_b64_tr_b16 a[28:29], v110 offset:18432
    ds_read_b64_tr_b16 a[30:31], v110 offset:18944
    v_mfma_f32_32x32x16_bf16 v[84:99], a[56:59], a[44:47], v[84:99]
    v_mfma_f32_32x32x16_bf16 v[4:19], a[48:51], a[72:75], v[4:19]
    v_mfma_f32_32x32x16_bf16 v[20:35], a[52:55], a[72:75], v[20:35]
    v_mfma_f32_32x32x16_bf16 v[36:51], a[48:51], a[76:79], v[36:51]
    v_mfma_f32_32x32x16_bf16 v[52:67], a[52:55], a[76:79], v[52:67]
    v_mfma_f32_32x32x16_bf16 v[68:83], a[68:71], a[48:51], v[68:83]
    v_mfma_f32_32x32x16_bf16 v[84:99], a[68:71], a[52:55], v[84:99]
    s_waitcnt lgkmcnt(0)
    s_barrier
    ds_read_b128 a[40:43], v101 offset:0
    ds_read_b128 a[44:47], v101 offset:4096
    v_mfma_f32_32x32x16_bf16 v[4:19], a[0:3], a[20:23], v[4:19]
    ds_read_b64_tr_b16 a[60:61], v110 offset:25600
    ds_read_b64_tr_b16 a[62:63], v110 offset:26112
    ds_read_b64_tr_b16 a[64:65], v110 offset:26624
    v_mfma_f32_32x32x16_bf16 v[20:35], a[4:7], a[20:23], v[20:35]
    ds_read_b64_tr_b16 a[66:67], v110 offset:27136
    ds_read_b64_tr_b16 a[56:57], v110 offset:24576
    ds_read_b64_tr_b16 a[58:59], v110 offset:25088
    v_mfma_f32_32x32x16_bf16 v[36:51], a[0:3], a[24:27], v[36:51]
    ds_read_b128 a[48:51], v102 offset:0
    ds_read_b128 a[52:55], v102 offset:4096
    ds_read_b64_tr_b16 a[72:73], v110 offset:31744
    v_mfma_f32_32x32x16_bf16 v[52:67], a[4:7], a[24:27], v[52:67]
    ds_read_b64_tr_b16 a[74:75], v110 offset:32256
    ds_read_b64_tr_b16 a[76:77], v110 offset:32768
    ds_read_b64_tr_b16 a[78:79], v110 offset:33280
    v_mfma_f32_32x32x16_bf16 v[68:83], a[16:19], a[0:3], v[68:83]
    ds_read_b64_tr_b16 a[68:69], v110 offset:30720
    ds_read_b64_tr_b16 a[70:71], v110 offset:31232
    v_mfma_f32_32x32x16_bf16 v[84:99], a[16:19], a[4:7], v[84:99]
    v_mfma_f32_32x32x16_bf16 v[4:19], a[8:11], a[32:35], v[4:19]
    v_mfma_f32_32x32x16_bf16 v[20:35], a[12:15], a[32:35], v[20:35]
    v_mfma_f32_32x32x16_bf16 v[36:51], a[8:11], a[36:39], v[36:51]
    v_mfma_f32_32x32x16_bf16 v[52:67], a[12:15], a[36:39], v[52:67]
    v_mfma_f32_32x32x16_bf16 v[68:83], a[28:31], a[8:11], v[68:83]
    v_mfma_f32_32x32x16_bf16 v[84:99], a[28:31], a[12:15], v[84:99]
    s_waitcnt lgkmcnt(0)
    s_barrier
    ds_read_b128 a[0:3], v108 offset:16384
    ds_read_b128 a[4:7], v108 offset:20480
    v_mfma_f32_32x32x16_bf16 v[4:19], a[40:43], a[60:63], v[4:19]
    ds_read_b64_tr_b16 a[20:21], v110 offset:37888
    ds_read_b64_tr_b16 a[22:23], v110 offset:38400
    ds_read_b64_tr_b16 a[24:25], v110 offset:38912
    v_mfma_f32_32x32x16_bf16 v[20:35], a[44:47], a[60:63], v[20:35]
    ds_read_b64_tr_b16 a[26:27], v110 offset:39424
    ds_read_b64_tr_b16 a[16:17], v110 offset:36864
    ds_read_b64_tr_b16 a[18:19], v110 offset:37376
    v_mfma_f32_32x32x16_bf16 v[36:51], a[40:43], a[64:67], v[36:51]
    ds_read_b128 a[8:11], v100 offset:16384
    ds_read_b128 a[12:15], v100 offset:20480
    ds_read_b64_tr_b16 a[32:33], v110 offset:44032
    v_mfma_f32_32x32x16_bf16 v[52:67], a[44:47], a[64:67], v[52:67]
    ds_read_b64_tr_b16 a[34:35], v110 offset:44544
    ds_read_b64_tr_b16 a[36:37], v110 offset:45056
    ds_read_b64_tr_b16 a[38:39], v110 offset:45568
    v_mfma_f32_32x32x16_bf16 v[68:83], a[56:59], a[40:43], v[68:83]
    ds_read_b64_tr_b16 a[28:29], v110 offset:43008
    ds_read_b64_tr_b16 a[30:31], v110 offset:43520
    v_mfma_f32_32x32x16_bf16 v[84:99], a[56:59], a[44:47], v[84:99]
    v_mfma_f32_32x32x16_bf16 v[4:19], a[48:51], a[72:75], v[4:19]
    v_mfma_f32_32x32x16_bf16 v[20:35], a[52:55], a[72:75], v[20:35]
    v_mfma_f32_32x32x16_bf16 v[36:51], a[48:51], a[76:79], v[36:51]
    v_mfma_f32_32x32x16_bf16 v[52:67], a[52:55], a[76:79], v[52:67]
    v_mfma_f32_32x32x16_bf16 v[68:83], a[68:71], a[48:51], v[68:83]
    v_mfma_f32_32x32x16_bf16 v[84:99], a[68:71], a[52:55], v[84:99]
    s_waitcnt lgkmcnt(0)
    s_barrier
    ds_read_b128 a[40:43], v101 offset:16384
    ds_read_b128 a[44:47], v101 offset:20480
    v_mfma_f32_32x32x16_bf16 v[4:19], a[0:3], a[20:23], v[4:19]
    ds_read_b64_tr_b16 a[60:61], v103 offset:1024
    ds_read_b64_tr_b16 a[62:63], v103 offset:1536
    ds_read_b64_tr_b16 a[64:65], v103 offset:2048
    v_mfma_f32_32x32x16_bf16 v[20:35], a[4:7], a[20:23], v[20:35]
    ds_read_b64_tr_b16 a[66:67], v103 offset:2560
    ds_read_b64_tr_b16 a[56:57], v103 offset:0
    ds_read_b64_tr_b16 a[58:59], v103 offset:512
    v_mfma_f32_32x32x16_bf16 v[36:51], a[0:3], a[24:27], v[36:51]
    ds_read_b128 a[48:51], v102 offset:16384
    ds_read_b128 a[52:55], v102 offset:20480
    ds_read_b64_tr_b16 a[72:73], v103 offset:7168
    v_mfma_f32_32x32x16_bf16 v[52:67], a[4:7], a[24:27], v[52:67]
    ds_read_b64_tr_b16 a[74:75], v103 offset:7680
    ds_read_b64_tr_b16 a[76:77], v103 offset:8192
    ds_read_b64_tr_b16 a[78:79], v103 offset:8704
    v_mfma_f32_32x32x16_bf16 v[68:83], a[16:19], a[0:3], v[68:83]
    ds_read_b64_tr_b16 a[68:69], v103 offset:6144
    ds_read_b64_tr_b16 a[70:71], v103 offset:6656
    v_mfma_f32_32x32x16_bf16 v[84:99], a[16:19], a[4:7], v[84:99]
    v_mfma_f32_32x32x16_bf16 v[4:19], a[8:11], a[32:35], v[4:19]
    v_mfma_f32_32x32x16_bf16 v[20:35], a[12:15], a[32:35], v[20:35]
    v_mfma_f32_32x32x16_bf16 v[36:51], a[8:11], a[36:39], v[36:51]
    v_mfma_f32_32x32x16_bf16 v[52:67], a[12:15], a[36:39], v[52:67]
    v_mfma_f32_32x32x16_bf16 v[68:83], a[28:31], a[8:11], v[68:83]
    v_mfma_f32_32x32x16_bf16 v[84:99], a[28:31], a[12:15], v[84:99]
    s_waitcnt lgkmcnt(0)
    s_barrier
    ds_read_b128 a[0:3], v108 offset:32768
    ds_read_b128 a[4:7], v108 offset:36864
    v_mfma_f32_32x32x16_bf16 v[4:19], a[40:43], a[60:63], v[4:19]
    ds_read_b64_tr_b16 a[20:21], v103 offset:13312
    ds_read_b64_tr_b16 a[22:23], v103 offset:13824
    ds_read_b64_tr_b16 a[24:25], v103 offset:14336
    v_mfma_f32_32x32x16_bf16 v[20:35], a[44:47], a[60:63], v[20:35]
    ds_read_b64_tr_b16 a[26:27], v103 offset:14848
    ds_read_b64_tr_b16 a[16:17], v103 offset:12288
    ds_read_b64_tr_b16 a[18:19], v103 offset:12800
    v_mfma_f32_32x32x16_bf16 v[36:51], a[40:43], a[64:67], v[36:51]
    ds_read_b128 a[8:11], v100 offset:32768
    ds_read_b128 a[12:15], v100 offset:36864
    ds_read_b64_tr_b16 a[32:33], v103 offset:19456
    v_mfma_f32_32x32x16_bf16 v[52:67], a[44:47], a[64:67], v[52:67]
    ds_read_b64_tr_b16 a[34:35], v103 offset:19968
    ds_read_b64_tr_b16 a[36:37], v103 offset:20480
    ds_read_b64_tr_b16 a[38:39], v103 offset:20992
    v_mfma_f32_32x32x16_bf16 v[68:83], a[56:59], a[40:43], v[68:83]
    ds_read_b64_tr_b16 a[28:29], v103 offset:18432
    ds_read_b64_tr_b16 a[30:31], v103 offset:18944
    v_mfma_f32_32x32x16_bf16 v[84:99], a[56:59], a[44:47], v[84:99]
    v_mfma_f32_32x32x16_bf16 v[4:19], a[48:51], a[72:75], v[4:19]
    v_mfma_f32_32x32x16_bf16 v[20:35], a[52:55], a[72:75], v[20:35]
    v_mfma_f32_32x32x16_bf16 v[36:51], a[48:51], a[76:79], v[36:51]
    v_mfma_f32_32x32x16_bf16 v[52:67], a[52:55], a[76:79], v[52:67]
    v_mfma_f32_32x32x16_bf16 v[68:83], a[68:71], a[48:51], v[68:83]
    v_mfma_f32_32x32x16_bf16 v[84:99], a[68:71], a[52:55], v[84:99]
    s_waitcnt lgkmcnt(0)
    s_barrier
    buffer_load_dword v109, v104, s[52:55], s65 offen sc0 sc1
    ds_read_b128 a[40:43], v101 offset:32768
    ds_read_b128 a[44:47], v101 offset:36864
    v_mfma_f32_32x32x16_bf16 v[4:19], a[0:3], a[20:23], v[4:19]
    ds_read_b64_tr_b16 a[60:61], v103 offset:25600
    ds_read_b64_tr_b16 a[62:63], v103 offset:26112
    ds_read_b64_tr_b16 a[64:65], v103 offset:26624
    v_mfma_f32_32x32x16_bf16 v[20:35], a[4:7], a[20:23], v[20:35]
    ds_read_b64_tr_b16 a[66:67], v103 offset:27136
    ds_read_b64_tr_b16 a[56:57], v103 offset:24576
    ds_read_b64_tr_b16 a[58:59], v103 offset:25088
    v_mfma_f32_32x32x16_bf16 v[36:51], a[0:3], a[24:27], v[36:51]
    ds_read_b128 a[48:51], v102 offset:32768
    ds_read_b128 a[52:55], v102 offset:36864
    ds_read_b64_tr_b16 a[72:73], v103 offset:31744
    v_mfma_f32_32x32x16_bf16 v[52:67], a[4:7], a[24:27], v[52:67]
    ds_read_b64_tr_b16 a[74:75], v103 offset:32256
    ds_read_b64_tr_b16 a[76:77], v103 offset:32768
    ds_read_b64_tr_b16 a[78:79], v103 offset:33280
    v_mfma_f32_32x32x16_bf16 v[68:83], a[16:19], a[0:3], v[68:83]
    ds_read_b64_tr_b16 a[68:69], v103 offset:30720
    ds_read_b64_tr_b16 a[70:71], v103 offset:31232
    v_mfma_f32_32x32x16_bf16 v[84:99], a[16:19], a[4:7], v[84:99]
    v_mfma_f32_32x32x16_bf16 v[4:19], a[8:11], a[32:35], v[4:19]
    v_mfma_f32_32x32x16_bf16 v[20:35], a[12:15], a[32:35], v[20:35]
    v_mfma_f32_32x32x16_bf16 v[36:51], a[8:11], a[36:39], v[36:51]
    v_mfma_f32_32x32x16_bf16 v[52:67], a[12:15], a[36:39], v[52:67]
    v_mfma_f32_32x32x16_bf16 v[68:83], a[28:31], a[8:11], v[68:83]
    v_mfma_f32_32x32x16_bf16 v[84:99], a[28:31], a[12:15], v[84:99]
    s_waitcnt lgkmcnt(0)
    s_barrier
    ds_read_b128 a[0:3], v108 offset:49152
    ds_read_b128 a[4:7], v108 offset:53248
    v_mfma_f32_32x32x16_bf16 v[4:19], a[40:43], a[60:63], v[4:19]
    ds_read_b64_tr_b16 a[20:21], v110 offset:1024
    ds_read_b64_tr_b16 a[22:23], v110 offset:1536
    ds_read_b64_tr_b16 a[24:25], v110 offset:2048
    v_mfma_f32_32x32x16_bf16 v[20:35], a[44:47], a[60:63], v[20:35]
    ds_read_b64_tr_b16 a[26:27], v110 offset:2560
    ds_read_b64_tr_b16 a[16:17], v110 offset:0
    ds_read_b64_tr_b16 a[18:19], v110 offset:512
    v_mfma_f32_32x32x16_bf16 v[36:51], a[40:43], a[64:67], v[36:51]
    ds_read_b128 a[8:11], v100 offset:49152
    ds_read_b128 a[12:15], v100 offset:53248
    ds_read_b64_tr_b16 a[32:33], v110 offset:7168
    v_mfma_f32_32x32x16_bf16 v[52:67], a[44:47], a[64:67], v[52:67]
    ds_read_b64_tr_b16 a[34:35], v110 offset:7680
    ds_read_b64_tr_b16 a[36:37], v110 offset:8192
    ds_read_b64_tr_b16 a[38:39], v110 offset:8704
    v_mfma_f32_32x32x16_bf16 v[68:83], a[56:59], a[40:43], v[68:83]
    ds_read_b64_tr_b16 a[28:29], v110 offset:6144
    ds_read_b64_tr_b16 a[30:31], v110 offset:6656
    v_mfma_f32_32x32x16_bf16 v[84:99], a[56:59], a[44:47], v[84:99]
    v_mfma_f32_32x32x16_bf16 v[4:19], a[48:51], a[72:75], v[4:19]
    v_mfma_f32_32x32x16_bf16 v[20:35], a[52:55], a[72:75], v[20:35]
    v_mfma_f32_32x32x16_bf16 v[36:51], a[48:51], a[76:79], v[36:51]
    v_mfma_f32_32x32x16_bf16 v[52:67], a[52:55], a[76:79], v[52:67]
    v_mfma_f32_32x32x16_bf16 v[68:83], a[68:71], a[48:51], v[68:83]
    v_mfma_f32_32x32x16_bf16 v[84:99], a[68:71], a[52:55], v[84:99]
    s_waitcnt lgkmcnt(0)
    s_barrier
    ds_read_b128 a[40:43], v101 offset:49152
    ds_read_b128 a[44:47], v101 offset:53248
    v_mfma_f32_32x32x16_bf16 v[4:19], a[0:3], a[20:23], v[4:19]
    ds_read_b64_tr_b16 a[60:61], v110 offset:13312
    ds_read_b64_tr_b16 a[62:63], v110 offset:13824
    ds_read_b64_tr_b16 a[64:65], v110 offset:14336
    v_mfma_f32_32x32x16_bf16 v[20:35], a[4:7], a[20:23], v[20:35]
    ds_read_b64_tr_b16 a[66:67], v110 offset:14848
    ds_read_b64_tr_b16 a[56:57], v110 offset:12288
    ds_read_b64_tr_b16 a[58:59], v110 offset:12800
    v_mfma_f32_32x32x16_bf16 v[4:19], a[8:11], a[32:35], v[4:19]
    ds_read_b128 a[48:51], v102 offset:49152
    ds_read_b128 a[52:55], v102 offset:53248
    ds_read_b64_tr_b16 a[72:73], v110 offset:19456
    v_mfma_f32_32x32x16_bf16 v[20:35], a[12:15], a[32:35], v[20:35]
    ds_read_b64_tr_b16 a[74:75], v110 offset:19968
    ds_read_b64_tr_b16 a[76:77], v110 offset:20480
    ds_read_b64_tr_b16 a[78:79], v110 offset:20992
    ds_read_b64_tr_b16 a[68:69], v110 offset:18432
    ds_read_b64_tr_b16 a[70:71], v110 offset:18944
    s_waitcnt lgkmcnt(8)
    v_mfma_f32_32x32x16_bf16 v[4:19], a[40:43], a[60:63], v[4:19]
    v_mfma_f32_32x32x16_bf16 v[20:35], a[44:47], a[60:63], v[20:35]
    s_waitcnt lgkmcnt(0)
    v_mfma_f32_32x32x16_bf16 v[4:19], a[48:51], a[72:75], v[4:19]
    v_mfma_f32_32x32x16_bf16 v[20:35], a[52:55], a[72:75], v[20:35]
    v_mfma_f32_32x32x16_bf16 v[36:51], a[0:3], a[24:27], v[36:51]
    v_mfma_f32_32x32x16_bf16 v[36:51], a[8:11], a[36:39], v[36:51]
    s_waitcnt vmcnt(0)
Lwf_12:
    v_xor_b32 v109, s66, v109
    v_cmp_ne_u32 vcc, 0, v109
    s_nop 7
    s_cbranch_vccnz Lrt_13
Lrk_14:
    v_pk_fma_f32 v[100:101], v[4:5], s[80:81], v[120:121]
    v_pk_fma_f32 v[102:103], v[6:7], s[80:81], v[120:121]
    v_pk_fma_f32 v[104:105], v[8:9], s[80:81], v[120:121]
    v_pk_fma_f32 v[106:107], v[10:11], s[80:81], v[120:121]
    v_exp_f32 v100, v100 clamp
    v_max_f32 v4, s90, v4
    v_exp_f32 v101, v101 clamp
    v_max_f32 v5, s90, v5
    s_add_u32 s74, s75, 20480
    v_mfma_f32_32x32x16_bf16 v[36:51], a[40:43], a[64:67], v[36:51]
    buffer_load_dwordx4 a[80:83], v127, s[52:55], s74 offen offset:0
    v_pk_add_f32 v[4:5], v[4:5], v[100:101]
    v_cvt_pk_bf16_f32 v4, v4, v5
    v_exp_f32 v102, v102 clamp
    v_max_f32 v6, s90, v6
    v_exp_f32 v103, v103 clamp
    v_max_f32 v7, s90, v7
    v_pk_add_f32 v[6:7], v[6:7], v[102:103]
    v_cvt_pk_bf16_f32 v5, v6, v7
    v_mfma_f32_32x32x16_bf16 v[36:51], a[48:51], a[76:79], v[36:51]
    buffer_load_dwordx4 a[84:87], v127, s[52:55], s74 offen offset:1024
    v_exp_f32 v104, v104 clamp
    v_max_f32 v8, s90, v8
    v_exp_f32 v105, v105 clamp
    v_max_f32 v9, s90, v9
    v_pk_add_f32 v[8:9], v[8:9], v[104:105]
    v_cvt_pk_bf16_f32 v6, v8, v9
    v_exp_f32 v106, v106 clamp
    v_max_f32 v10, s90, v10
    v_mfma_f32_32x32x16_bf16 v[52:67], a[4:7], a[24:27], v[52:67]
    buffer_load_dwordx4 a[88:91], v127, s[52:55], s74 offen offset:2048
    v_exp_f32 v107, v107 clamp
    v_max_f32 v11, s90, v11
    v_pk_add_f32 v[10:11], v[10:11], v[106:107]
    v_cvt_pk_bf16_f32 v7, v10, v11
    v_pk_fma_f32 v[100:101], v[12:13], s[80:81], v[120:121]
    v_pk_fma_f32 v[102:103], v[14:15], s[80:81], v[120:121]
    v_pk_fma_f32 v[104:105], v[16:17], s[80:81], v[120:121]
    v_pk_fma_f32 v[106:107], v[18:19], s[80:81], v[120:121]
    v_mfma_f32_32x32x16_bf16 v[52:67], a[12:15], a[36:39], v[52:67]
    buffer_load_dwordx4 a[92:95], v127, s[52:55], s74 offen offset:3072
    v_exp_f32 v100, v100 clamp
    v_max_f32 v12, s90, v12
    v_exp_f32 v101, v101 clamp
    v_max_f32 v13, s90, v13
    v_pk_add_f32 v[12:13], v[12:13], v[100:101]
    v_cvt_pk_bf16_f32 v8, v12, v13
    v_exp_f32 v102, v102 clamp
    v_max_f32 v14, s90, v14
    v_mfma_f32_32x32x16_bf16 v[52:67], a[44:47], a[64:67], v[52:67]
    s_add_u32 s74, s75, 24576
    buffer_load_dwordx4 a[96:99], v127, s[52:55], s74 offen offset:0
    v_exp_f32 v103, v103 clamp
    v_max_f32 v15, s90, v15
    v_pk_add_f32 v[14:15], v[14:15], v[102:103]
    v_cvt_pk_bf16_f32 v9, v14, v15
    v_exp_f32 v104, v104 clamp
    v_max_f32 v16, s90, v16
    v_exp_f32 v105, v105 clamp
    v_mfma_f32_32x32x16_bf16 v[52:67], a[52:55], a[76:79], v[52:67]
    v_max_f32 v17, s90, v17
    buffer_load_dwordx4 a[100:103], v127, s[52:55], s74 offen offset:1024
    v_pk_add_f32 v[16:17], v[16:17], v[104:105]
    v_cvt_pk_bf16_f32 v10, v16, v17
    v_exp_f32 v106, v106 clamp
    v_max_f32 v18, s90, v18
    v_exp_f32 v107, v107 clamp
    v_max_f32 v19, s90, v19
    v_pk_add_f32 v[18:19], v[18:19], v[106:107]
    v_cvt_pk_bf16_f32 v11, v18, v19
    buffer_load_dwordx4 a[104:107], v127, s[52:55], s74 offen offset:2048
    v_cvt_pk_bf16_f32 v36, v36, v37
    v_cvt_pk_bf16_f32 v37, v38, v39
    v_cvt_pk_bf16_f32 v38, v40, v41
    v_cvt_pk_bf16_f32 v39, v42, v43
    v_cvt_pk_bf16_f32 v40, v44, v45
    v_cvt_pk_bf16_f32 v41, v46, v47
    v_cvt_pk_bf16_f32 v42, v48, v49
    v_cvt_pk_bf16_f32 v43, v50, v51
    v_mfma_f32_32x32x16_bf16 v[68:83], a[16:19], a[0:3], v[68:83]
    v_cvt_pk_bf16_f32 v44, v52, v53
    v_cvt_pk_bf16_f32 v45, v54, v55
    v_cvt_pk_bf16_f32 v46, v56, v57
    v_cvt_pk_bf16_f32 v47, v58, v59
    v_cvt_pk_bf16_f32 v48, v60, v61
    v_cvt_pk_bf16_f32 v49, v62, v63
    v_cvt_pk_bf16_f32 v50, v64, v65
    v_mfma_f32_32x32x16_bf16 v[68:83], a[28:31], a[8:11], v[68:83]
    v_cvt_pk_bf16_f32 v51, v66, v67
    v_pk_fma_f32 v[100:101], v[20:21], s[80:81], v[120:121]
    v_pk_fma_f32 v[102:103], v[22:23], s[80:81], v[120:121]
    v_pk_fma_f32 v[104:105], v[24:25], s[80:81], v[120:121]
    v_pk_fma_f32 v[106:107], v[26:27], s[80:81], v[120:121]
    v_exp_f32 v100, v100 clamp
    v_max_f32 v20, s90, v20
    buffer_load_dwordx4 a[108:111], v127, s[52:55], s74 offen offset:3072
    v_mfma_f32_32x32x16_bf16 v[52:67], v[4:7], v[36:39], 0
    v_exp_f32 v101, v101 clamp
    v_max_f32 v21, s90, v21
    v_pk_add_f32 v[20:21], v[20:21], v[100:101]
    v_cvt_pk_bf16_f32 v12, v20, v21
    v_exp_f32 v102, v102 clamp
    v_max_f32 v22, s90, v22
    v_mfma_f32_32x32x16_bf16 a[112:127], v[116:119], v[4:7], 0
    v_exp_f32 v103, v103 clamp
    v_max_f32 v23, s90, v23
    v_pk_add_f32 v[22:23], v[22:23], v[102:103]
    v_cvt_pk_bf16_f32 v13, v22, v23
    v_exp_f32 v104, v104 clamp
    v_max_f32 v24, s90, v24
    v_mfma_f32_32x32x16_bf16 v[52:67], v[8:11], v[40:43], v[52:67]
    v_exp_f32 v105, v105 clamp
    v_max_f32 v25, s90, v25
    v_pk_add_f32 v[24:25], v[24:25], v[104:105]
    v_cvt_pk_bf16_f32 v14, v24, v25
    v_exp_f32 v106, v106 clamp
    v_max_f32 v26, s90, v26
    v_mfma_f32_32x32x16_bf16 a[112:127], v[116:119], v[8:11], a[112:127]
    v_exp_f32 v107, v107 clamp
    v_max_f32 v27, s90, v27
    v_pk_add_f32 v[26:27], v[26:27], v[106:107]
    v_cvt_pk_bf16_f32 v15, v26, v27
    v_pk_fma_f32 v[100:101], v[28:29], s[80:81], v[120:121]
    v_pk_fma_f32 v[102:103], v[30:31], s[80:81], v[120:121]
    v_pk_fma_f32 v[104:105], v[32:33], s[80:81], v[120:121]
    v_pk_fma_f32 v[106:107], v[34:35], s[80:81], v[120:121]
    v_exp_f32 v100, v100 clamp
    v_max_f32 v28, s90, v28
    v_exp_f32 v101, v101 clamp
    v_max_f32 v29, s90, v29
    v_mfma_f32_32x32x16_bf16 v[52:67], v[12:15], v[44:47], v[52:67]
    v_pk_add_f32 v[28:29], v[28:29], v[100:101]
    v_cvt_pk_bf16_f32 v16, v28, v29
    v_exp_f32 v102, v102 clamp
    v_max_f32 v30, s90, v30
    v_exp_f32 v103, v103 clamp
    v_max_f32 v31, s90, v31
    v_pk_add_f32 v[30:31], v[30:31], v[102:103]
    v_cvt_pk_bf16_f32 v17, v30, v31
    v_mfma_f32_32x32x16_bf16 a[112:127], v[116:119], v[12:15], a[112:127]
    v_exp_f32 v104, v104 clamp
    v_max_f32 v32, s90, v32
    v_exp_f32 v105, v105 clamp
    v_max_f32 v33, s90, v33
    v_pk_add_f32 v[32:33], v[32:33], v[104:105]
    v_cvt_pk_bf16_f32 v18, v32, v33
    v_exp_f32 v106, v106 clamp
    v_max_f32 v34, s90, v34
    v_exp_f32 v107, v107 clamp
    v_max_f32 v35, s90, v35
    v_pk_add_f32 v[34:35], v[34:35], v[106:107]
    v_cvt_pk_bf16_f32 v19, v34, v35
    s_nop 1
    v_mfma_f32_32x32x16_bf16 v[52:67], v[16:19], v[48:51], v[52:67]
    v_mfma_f32_32x32x16_bf16 a[112:127], v[116:119], v[16:19], a[112:127]
    s_nop 10
    v_cndmask_b32 v52, v60, v52, s[86:87]
    v_cndmask_b32 v53, v61, v53, s[86:87]
    v_cndmask_b32 v54, v62, v54, s[86:87]
    v_cndmask_b32 v55, v63, v55, s[86:87]
    ds_write_b128 v111, v[52:55] offset:0
    v_cndmask_b32 v56, v64, v56, s[86:87]
    v_cndmask_b32 v57, v65, v57, s[86:87]
    v_cndmask_b32 v58, v66, v58, s[86:87]
    v_cndmask_b32 v59, v67, v59, s[86:87]
    ds_write_b128 v111, v[56:59] offset:512
    ds_write_b32 v112, a112
    v_mfma_f32_32x32x16_bf16 v[68:83], a[56:59], a[40:43], v[68:83]
    v_mfma_f32_32x32x16_bf16 v[68:83], a[68:71], a[48:51], v[68:83]
    s_waitcnt lgkmcnt(0)
    s_barrier
    v_mfma_f32_32x32x16_bf16 v[84:99], a[16:19], a[4:7], v[84:99]
    v_mfma_f32_32x32x16_bf16 v[84:99], a[28:31], a[12:15], v[84:99]
    v_mfma_f32_32x32x16_bf16 v[84:99], a[56:59], a[44:47], v[84:99]
    v_mfma_f32_32x32x16_bf16 v[84:99], a[68:71], a[52:55], v[84:99]
    s_nop 5
    v_pk_fma_f32 v[100:101], v[68:69], s[80:81], v[120:121]
    v_pk_fma_f32 v[102:103], v[70:71], s[80:81], v[120:121]
    v_pk_fma_f32 v[104:105], v[72:73], s[80:81], v[120:121]
    s_add_u32 s74, s75, 0
    buffer_load_dwordx4 a[0:3], v127, s[52:55], s74 offen offset:0
    v_pk_fma_f32 v[106:107], v[74:75], s[80:81], v[120:121]
    v_exp_f32 v100, v100 clamp
    v_max_f32 v68, s90, v68
    buffer_load_dwordx4 a[4:7], v127, s[52:55], s74 offen offset:1024
    v_exp_f32 v101, v101 clamp
    v_max_f32 v69, s90, v69
    v_pk_add_f32 v[68:69], v[68:69], v[100:101]
    buffer_load_dwordx4 a[8:11], v127, s[52:55], s74 offen offset:2048
    v_cvt_pk_bf16_f32 v68, v68, v69
    v_exp_f32 v102, v102 clamp
    v_max_f32 v70, s90, v70
    buffer_load_dwordx4 a[12:15], v127, s[52:55], s74 offen offset:3072
    v_exp_f32 v103, v103 clamp
    v_max_f32 v71, s90, v71
    v_pk_add_f32 v[70:71], v[70:71], v[102:103]
    s_add_u32 s74, s75, 4096
    buffer_load_dwordx4 a[16:19], v127, s[52:55], s74 offen offset:0
    v_cvt_pk_bf16_f32 v69, v70, v71
    v_exp_f32 v104, v104 clamp
    v_max_f32 v72, s90, v72
    buffer_load_dwordx4 a[20:23], v127, s[52:55], s74 offen offset:1024
    v_exp_f32 v105, v105 clamp
    v_max_f32 v73, s90, v73
    v_pk_add_f32 v[72:73], v[72:73], v[104:105]
    buffer_load_dwordx4 a[24:27], v127, s[52:55], s74 offen offset:2048
    v_cvt_pk_bf16_f32 v70, v72, v73
    v_exp_f32 v106, v106 clamp
    v_max_f32 v74, s90, v74
    buffer_load_dwordx4 a[28:31], v127, s[52:55], s74 offen offset:3072
    v_exp_f32 v107, v107 clamp
    v_max_f32 v75, s90, v75
    v_pk_add_f32 v[74:75], v[74:75], v[106:107]
    s_add_u32 s74, s75, 8192
    buffer_load_dwordx4 a[32:35], v127, s[52:55], s74 offen offset:0
    v_cvt_pk_bf16_f32 v71, v74, v75
    v_pk_fma_f32 v[100:101], v[76:77], s[80:81], v[120:121]
    v_pk_fma_f32 v[102:103], v[78:79], s[80:81], v[120:121]
    buffer_load_dwordx4 a[36:39], v127, s[52:55], s74 offen offset:1024
    v_pk_fma_f32 v[104:105], v[80:81], s[80:81], v[120:121]
    v_pk_fma_f32 v[106:107], v[82:83], s[80:81], v[120:121]
    v_exp_f32 v100, v100 clamp
    buffer_load_dwordx4 a[40:43], v127, s[52:55], s74 offen offset:2048
    v_max_f32 v76, s90, v76
    v_exp_f32 v101, v101 clamp
    v_max_f32 v77, s90, v77
    buffer_load_dwordx4 a[44:47], v127, s[52:55], s74 offen offset:3072
    v_pk_add_f32 v[76:77], v[76:77], v[100:101]
    v_cvt_pk_bf16_f32 v72, v76, v77
    v_exp_f32 v102, v102 clamp
    s_add_u32 s74, s75, 12288
    buffer_load_dwordx4 a[48:51], v127, s[52:55], s74 offen offset:0
    v_max_f32 v78, s90, v78
    v_exp_f32 v103, v103 clamp
    v_max_f32 v79, s90, v79
    buffer_load_dwordx4 a[52:55], v127, s[52:55], s74 offen offset:1024
    v_pk_add_f32 v[78:79], v[78:79], v[102:103]
    v_cvt_pk_bf16_f32 v73, v78, v79
    v_exp_f32 v104, v104 clamp
    buffer_load_dwordx4 a[56:59], v127, s[52:55], s74 offen offset:2048
    v_max_f32 v80, s90, v80
    v_exp_f32 v105, v105 clamp
    v_max_f32 v81, s90, v81
    buffer_load_dwordx4 a[60:63], v127, s[52:55], s74 offen offset:3072
    v_pk_add_f32 v[80:81], v[80:81], v[104:105]
    v_cvt_pk_bf16_f32 v74, v80, v81
    v_exp_f32 v106, v106 clamp
    s_add_u32 s74, s75, 16384
    buffer_load_dwordx4 a[64:67], v127, s[52:55], s74 offen offset:0
    v_max_f32 v82, s90, v82
    v_exp_f32 v107, v107 clamp
    v_max_f32 v83, s90, v83
    buffer_load_dwordx4 a[68:71], v127, s[52:55], s74 offen offset:1024
    v_pk_add_f32 v[82:83], v[82:83], v[106:107]
    v_cvt_pk_bf16_f32 v75, v82, v83
    v_pk_fma_f32 v[100:101], v[84:85], s[80:81], v[120:121]
    buffer_load_dwordx4 a[72:75], v127, s[52:55], s74 offen offset:2048
    v_pk_fma_f32 v[102:103], v[86:87], s[80:81], v[120:121]
    v_pk_fma_f32 v[104:105], v[88:89], s[80:81], v[120:121]
    v_pk_fma_f32 v[106:107], v[90:91], s[80:81], v[120:121]
    buffer_load_dwordx4 a[76:79], v127, s[52:55], s74 offen offset:3072
    v_exp_f32 v100, v100 clamp
    v_max_f32 v84, s90, v84
    v_exp_f32 v101, v101 clamp
    s_add_u32 s74, s75, 28672
    buffer_load_dwordx4 a[112:115], v127, s[52:55], s74 offen offset:0
    v_max_f32 v85, s90, v85
    v_pk_add_f32 v[84:85], v[84:85], v[100:101]
    v_cvt_pk_bf16_f32 v76, v84, v85
    buffer_load_dwordx4 a[116:119], v127, s[52:55], s74 offen offset:1024
    v_exp_f32 v102, v102 clamp
    v_max_f32 v86, s90, v86
    v_exp_f32 v103, v103 clamp
    buffer_load_dwordx4 a[120:123], v127, s[52:55], s74 offen offset:2048
    v_max_f32 v87, s90, v87
    v_pk_add_f32 v[86:87], v[86:87], v[102:103]
    v_cvt_pk_bf16_f32 v77, v86, v87
    buffer_load_dwordx4 a[124:127], v127, s[52:55], s74 offen offset:3072
    v_exp_f32 v104, v104 clamp
    v_max_f32 v88, s90, v88
    v_exp_f32 v105, v105 clamp
    v_max_f32 v89, s90, v89
    v_pk_add_f32 v[88:89], v[88:89], v[104:105]
    v_cvt_pk_bf16_f32 v78, v88, v89
    v_exp_f32 v106, v106 clamp
    v_max_f32 v90, s90, v90
    v_exp_f32 v107, v107 clamp
    v_max_f32 v91, s90, v91
    v_pk_add_f32 v[90:91], v[90:91], v[106:107]
    v_cvt_pk_bf16_f32 v79, v90, v91
    v_pk_fma_f32 v[100:101], v[92:93], s[80:81], v[120:121]
    v_pk_fma_f32 v[102:103], v[94:95], s[80:81], v[120:121]
    v_pk_fma_f32 v[104:105], v[96:97], s[80:81], v[120:121]
    v_pk_fma_f32 v[106:107], v[98:99], s[80:81], v[120:121]
    v_exp_f32 v100, v100 clamp
    v_max_f32 v92, s90, v92
    v_exp_f32 v101, v101 clamp
    v_max_f32 v93, s90, v93
    v_pk_add_f32 v[92:93], v[92:93], v[100:101]
    v_cvt_pk_bf16_f32 v80, v92, v93
    v_exp_f32 v102, v102 clamp
    v_max_f32 v94, s90, v94
    v_exp_f32 v103, v103 clamp
    v_max_f32 v95, s90, v95
    v_pk_add_f32 v[94:95], v[94:95], v[102:103]
    v_cvt_pk_bf16_f32 v81, v94, v95
    v_exp_f32 v104, v104 clamp
    v_max_f32 v96, s90, v96
    v_exp_f32 v105, v105 clamp
    v_max_f32 v97, s90, v97
    v_pk_add_f32 v[96:97], v[96:97], v[104:105]
    v_cvt_pk_bf16_f32 v82, v96, v97
    v_exp_f32 v106, v106 clamp
    v_max_f32 v98, s90, v98
    v_exp_f32 v107, v107 clamp
    v_max_f32 v99, s90, v99
    v_pk_add_f32 v[98:99], v[98:99], v[106:107]
    v_cvt_pk_bf16_f32 v83, v98, v99
    s_barrier
    ds_read_b128 v[84:87], v115
    ds_read_b128 v[88:91], v115 offset:544
    s_waitcnt lgkmcnt(1)
    v_mfma_f32_32x32x16_bf16 v[4:19], v[84:87], v[68:71], 0
    v_mfma_f32_32x32x16_bf16 v[20:35], v[84:87], v[76:79], 0
    s_waitcnt lgkmcnt(0)
    v_mfma_f32_32x32x16_bf16 v[36:51], v[88:91], v[72:75], 0
    v_mfma_f32_32x32x16_bf16 v[52:67], v[88:91], v[80:83], 0
    s_nop 7
    v_add_f32 v12, s90, v12
    v_rcp_f32 v12, v12
    s_nop 0
    v_pk_mul_f32 v[4:5], v[4:5], v[12:13] op_sel_hi:[1,0]
    v_pk_mul_f32 v[6:7], v[6:7], v[12:13] op_sel_hi:[1,0]
    v_pk_mul_f32 v[8:9], v[8:9], v[12:13] op_sel_hi:[1,0]
    v_pk_mul_f32 v[10:11], v[10:11], v[12:13] op_sel_hi:[1,0]
    v_cvt_pk_bf16_f32 v92, v4, v5
    v_bfi_b32 v92, v126, v122, v92
    v_cvt_pk_bf16_f32 v93, v6, v7
    v_bfi_b32 v93, v126, v123, v93
    v_cvt_pk_bf16_f32 v94, v8, v9
    v_bfi_b32 v94, v126, v124, v94
    v_cvt_pk_bf16_f32 v95, v10, v11
    v_bfi_b32 v95, v126, v125, v95
    buffer_store_dwordx4 v[92:95], v127, s[52:55], s78 offen offset:0 sc0 sc1
    v_add_f32 v28, s90, v28
    v_rcp_f32 v28, v28
    s_nop 0
    v_pk_mul_f32 v[20:21], v[20:21], v[28:29] op_sel_hi:[1,0]
    v_pk_mul_f32 v[22:23], v[22:23], v[28:29] op_sel_hi:[1,0]
    v_pk_mul_f32 v[24:25], v[24:25], v[28:29] op_sel_hi:[1,0]
    v_pk_mul_f32 v[26:27], v[26:27], v[28:29] op_sel_hi:[1,0]
    v_cvt_pk_bf16_f32 v96, v20, v21
    v_bfi_b32 v96, v126, v122, v96
    v_cvt_pk_bf16_f32 v97, v22, v23
    v_bfi_b32 v97, v126, v123, v97
    v_cvt_pk_bf16_f32 v98, v24, v25
    v_bfi_b32 v98, v126, v124, v98
    v_cvt_pk_bf16_f32 v99, v26, v27
    v_bfi_b32 v99, v126, v125, v99
    buffer_store_dwordx4 v[96:99], v127, s[52:55], s77 offen offset:0 sc0 sc1
    v_add_f32 v44, s90, v44
    v_rcp_f32 v44, v44
    s_nop 0
    v_pk_mul_f32 v[36:37], v[36:37], v[44:45] op_sel_hi:[1,0]
    v_pk_mul_f32 v[38:39], v[38:39], v[44:45] op_sel_hi:[1,0]
    v_pk_mul_f32 v[40:41], v[40:41], v[44:45] op_sel_hi:[1,0]
    v_pk_mul_f32 v[42:43], v[42:43], v[44:45] op_sel_hi:[1,0]
    v_cvt_pk_bf16_f32 v92, v36, v37
    v_bfi_b32 v92, v126, v122, v92
    v_cvt_pk_bf16_f32 v93, v38, v39
    v_bfi_b32 v93, v126, v123, v93
    v_cvt_pk_bf16_f32 v94, v40, v41
    v_bfi_b32 v94, v126, v124, v94
    v_cvt_pk_bf16_f32 v95, v42, v43
    v_bfi_b32 v95, v126, v125, v95
    buffer_store_dwordx4 v[92:95], v127, s[52:55], s78 offen offset:1024 sc0 sc1
    v_add_f32 v60, s90, v60
    v_rcp_f32 v60, v60
    s_nop 0
    v_pk_mul_f32 v[52:53], v[52:53], v[60:61] op_sel_hi:[1,0]
    v_pk_mul_f32 v[54:55], v[54:55], v[60:61] op_sel_hi:[1,0]
    v_pk_mul_f32 v[56:57], v[56:57], v[60:61] op_sel_hi:[1,0]
    v_pk_mul_f32 v[58:59], v[58:59], v[60:61] op_sel_hi:[1,0]
    v_cvt_pk_bf16_f32 v96, v52, v53
    v_bfi_b32 v96, v126, v122, v96
    v_cvt_pk_bf16_f32 v97, v54, v55
    v_bfi_b32 v97, v126, v123, v97
    v_cvt_pk_bf16_f32 v98, v56, v57
    v_bfi_b32 v98, v126, v124, v98
    v_cvt_pk_bf16_f32 v99, v58, v59
    v_bfi_b32 v99, v126, v125, v99
    buffer_store_dwordx4 v[96:99], v127, s[52:55], s77 offen offset:1024 sc0 sc1
    v_lshrrev_b32 v4, 2, v1
    v_mul_u32_u24 v4, 80, v4
    v_and_b32 v5, 3, v1
    v_lshl_add_u32 v117, v5, 4, v4
    s_waitcnt vmcnt(4)
    s_branch L_fcomp
Lrt_13:
    s_cmp_eq_u32 s68, 0
    s_cbranch_scc1 Lrk_14
    s_sub_u32 s68, s68, 1
    s_sleep 6
    v_and_b32 v104, 7, v1
    v_lshlrev_b32 v104, 7, v104
    buffer_load_dword v109, v104, s[52:55], s65 offen sc0 sc1
    s_waitcnt vmcnt(0)
    s_branch Lwf_12
L_roleA:
    s_setprio 3
    s_getpc_b64 s[22:23]
Lpf_15:
    v_lshlrev_b32 v2, 7, v0
    v_min_u32 v2, L_end-Lpf_15, v2
    global_load_dword v113, v2, s[22:23]
    s_mov_b32 s59, s70
    s_mov_b32 s60, s71
    s_lshr_b32 s72, s71, 1
    s_lshl_b32 s57, s72, 3
    s_add_u32 s57, s57, s70
    s_and_b32 s58, s71, 1
    s_lshr_b32 s62, s71, 2
    s_and_b32 s89, s71, 3
    s_lshl_b32 s64, s70, 2
    s_add_u32 s64, s64, s62
    s_lshl_b32 s64, s64, 1
    s_add_u32 s64, s64, 1
    s_lshl_b32 s61, s70, 1
    s_add_u32 s61, s61, s58
    s_and_b32 s73, s72, 1
    s_lshl_b32 s73, s73, 4
    s_add_u32 s61, s61, s73
    s_cmp_eq_u32 s62, 3
    s_cselect_b32 s76, 4, 0xff
    s_lshl_b32 s70, s57, 1
    s_add_u32 s70, s70, s58
    s_lshl_b32 s70, s70, 2
    s_add_u32 s65, s70, s63
    s_and_b32 s70, s65, 31
    s_lshl_b32 s70, s70, 14
    s_lshr_b32 s71, s65, 5
    s_lshl_b32 s71, s71, 6
    s_add_u32 s74, s70, s71
    s_lshl_b32 s79, s56, 10
    s_add_u32 s79, s79, 32768
    v_lshrrev_b32 v4, 2, v1
    v_and_b32 v5, 3, v1
    v_lshlrev_b32 v6, 4, v5
    v_lshl_add_u32 v65, v4, 10, v6
    v_mul_u32_u24 v4, 80, v4
    v_add_u32 v117, v4, v6
    v_add_u32 v112, 53248, v127
    s_lshl_b32 s70, s56, 18
    s_lshl_b32 s71, s57, 10
    s_add_u32 s69, s70, s71
    s_lshl_b32 m0, s56, 12
    s_waitcnt lgkmcnt(0)
    s_mov_b64 s[24:25], s[4:5]
    s_mov_b32 s26, 2097152
    s_mov_b32 s27, 0x20000
    s_cmp_lt_u32 s56, 4
    s_cbranch_scc1 Lnowo_16
    s_mov_b64 s[44:45], s[14:15]
    s_mov_b32 s46, 524288
    s_mov_b32 s47, 0x20000
    s_mov_b32 m0, s79
    s_nop 0
    buffer_load_dwordx4 v65, s[44:47], s74 offen nt lds
    s_lshl_b32 m0, s56, 12
Lnowo_16:
    s_nop 0
    buffer_load_dwordx4 v127, s[24:27], s69 offen nt lds
    s_add_u32 s69, s69, 64512
    buffer_load_dwordx4 v127, s[24:27], s69 offen offset:1024 nt lds
    s_add_u32 s69, s69, 64512
    buffer_load_dwordx4 v127, s[24:27], s69 offen offset:2048 nt lds
    s_add_u32 s69, s69, 64512
    buffer_load_dwordx4 v127, s[24:27], s69 offen offset:3072 nt lds
    s_add_u32 s22, s20, 5373952
    s_addc_u32 s23, s21, 0
    s_load_dword s67, s[22:23], 0
    s_setprio 0
    s_mov_b64 s[36:37], s[10:11]
    s_mov_b32 s38, 2097152
    s_mov_b32 s39, 0x20000
    s_mov_b64 s[40:41], s[12:13]
    s_mov_b32 s42, 1572864
    s_mov_b32 s43, 0x20000
    s_mov_b64 s[28:29], s[6:7]
    s_mov_b32 s30, 1052672
    s_mov_b32 s31, 0x20000
    s_mov_b64 s[32:33], s[8:9]
    s_mov_b32 s34, 1052672
    s_mov_b32 s35, 0x20000
    v_and_b32 v2, 15, v1
    v_lshrrev_b32 v3, 4, v1
    s_lshl_b32 s70, s58, 3
    s_add_u32 s70, s70, s56
    s_sub_u32 s71, 32, s70
    s_cmp_eq_u32 s70, 0
    s_cselect_b32 s71, 16, s71
    s_cselect_b32 s80, 0, 0.5
    s_sub_u32 s71, s71, s70
    s_lshr_b32 s73, s56, 1
    v_lshrrev_b32 v22, 2, v2
    v_and_b32 v23, 1, v2
    v_lshl_add_u32 v4, v22, 1, v23
    v_lshl_add_u32 v4, v4, 5, s70
    v_bfe_u32 v5, v2, 1, 1
    v_mad_u32_u24 v4, v5, s71, v4
    v_lshrrev_b32 v8, 1, v3
    v_cvt_f32_u32 v10, v5
    v_cvt_f32_u32 v4, v4
    v_mul_f32 v4, 0x3b000000, v4
    v_cvt_f32_u32 v9, v8
    v_add_f32 v10, -0.5, v10
    v_mul_f32 v9, s80, v9
    v_mul_f32 v10, v10, v9
    v_lshlrev_b32 v15, 1, v3
    v_and_b32 v15, 2, v15
    v_xor_b32 v16, s73, v15
    v_xor_b32 v17, 1, v16
    v_cvt_f32_u32 v16, v16
    v_cvt_f32_u32 v17, v17
    v_mul_f32 v11, 4.0, v4
    v_fma_f32 v18, v16, v11, v10
    v_fma_f32 v19, v17, v11, v10
    v_fmamk_f32 v36, v4, 0x00000000, v18
    v_fmamk_f32 v37, v4, 0x3f800000, v18
    v_fmamk_f32 v38, v4, 0x40000000, v18
    v_fmamk_f32 v39, v4, 0x40400000, v18
    v_fmamk_f32 v40, v4, 0x00000000, v19
    v_fmamk_f32 v41, v4, 0x3f800000, v19
    v_fmamk_f32 v42, v4, 0x40000000, v19
    v_fmamk_f32 v43, v4, 0x40400000, v19
    v_sin_f32 v44, v36
    v_cos_f32 v36, v36
    v_sin_f32 v45, v37
    v_cos_f32 v37, v37
    v_sin_f32 v46, v38
    v_cos_f32 v38, v38
    v_sin_f32 v47, v39
    v_cos_f32 v39, v39
    v_sin_f32 v48, v40
    v_cos_f32 v40, v40
    v_sin_f32 v49, v41
    v_cos_f32 v41, v41
    v_sin_f32 v50, v42
    v_cos_f32 v42, v42
    v_sin_f32 v51, v43
    v_cos_f32 v43, v43
    v_cvt_pk_bf16_f32 v76, v36, v37
    v_cvt_pk_bf16_f32 v80, -v44, -v45
    v_cvt_pk_bf16_f32 v77, v38, v39
    v_cvt_pk_bf16_f32 v81, -v46, -v47
    v_cvt_pk_bf16_f32 v78, v40, v41
    v_cvt_pk_bf16_f32 v82, -v48, -v49
    v_cvt_pk_bf16_f32 v79, v42, v43
    v_cvt_pk_bf16_f32 v83, -v50, -v51
    s_mov_b64 s[52:53], s[20:21]
    s_mov_b32 s54, 268435456
    s_mov_b32 s55, 0x20000
    s_mov_b32 s72, s70
    s_cmp_lt_u32 s56, 2
    s_cbranch_scc1 Ltsel_17
    s_cmp_ge_u32 s56, 4
    s_cbranch_scc1 Ltsel_17
    s_lshr_b32 s70, s60, 1
    s_bitcmp1_b32 s60, 0
    s_cbranch_scc1 Ltw_18
    s_lshr_b32 s71, s59, 1
    s_lshl_b32 s71, s71, 3
    s_add_u32 s70, s70, s71
    s_lshl_b32 s70, s70, 16
    s_lshl_b32 s71, s56, 7
    s_add_u32 s70, s70, s71
    v_lshlrev_b32 v26, 10, v1
    buffer_load_dword v113, v26, s[36:39], s70 offen
    s_branch Ltx_19
Ltw_18:
    s_lshl_b32 s71, s56, 3
    s_add_u32 s70, s70, s71
    s_mul_i32 s70, s70, 24576
    s_and_b32 s71, s59, 1
    s_lshl_b32 s71, s71, 9
    s_add_u32 s70, s70, s71
    s_add_u32 s70, s70, 1024
    v_lshrrev_b32 v26, 3, v1
    v_mul_u32_u24 v26, 3072, v26
    v_bfe_u32 v27, v1, 2, 1
    v_lshl_add_u32 v26, v27, 10, v26
    v_and_b32 v27, 3, v1
    v_lshl_add_u32 v26, v27, 7, v26
    buffer_load_dword v113, v26, s[40:43], s70 offen
Ltx_19:
Ltsel_17:
    s_cmp_ge_u32 s56, 2
    s_cbranch_scc1 Ltq_20
    s_cmp_lt_u32 s56, 0
    s_cbranch_scc1 Ltq_20
    s_lshl_b32 s70, s56, 4
    s_add_u32 s70, s70, s60
    s_mul_i32 s70, s70, 24576
    s_and_b32 s71, s59, 1
    s_lshl_b32 s71, s71, 9
    s_add_u32 s70, s70, s71
    v_bfe_u32 v26, v1, 2, 3
    v_mul_u32_u24 v26, 3072, v26
    v_and_b32 v27, 3, v1
    v_lshl_add_u32 v26, v27, 7, v26
    buffer_load_dword v113, v26, s[40:43], s70 offen
Ltq_20:
    s_mov_b32 s70, s72
    s_cmp_lt_u32 s56, 4
    s_cbranch_scc1 Lnowo_21
    v_bfe_u32 v66, v1, 2, 2
    v_lshrrev_b32 v67, 5, v1
    v_lshl_add_u32 v66, v67, 3, v66
    v_lshlrev_b32 v66, 6, v66
    v_lshl_add_u32 v66, v23, 5, v66
    v_bfe_u32 v67, v1, 1, 1
    v_lshl_add_u32 v66, v67, 3, v66
    v_and_b32 v67, 16, v1
    v_add3_u32 v66, v66, v67, s79
    s_lshr_b32 s73, s65, 5
    s_mul_i32 s73, s73, 4352
    s_lshl_b32 s71, s65, 10
    s_add_u32 s73, s73, s71
    s_add_u32 s73, s73, 8912896
    s_waitcnt vmcnt(4)
    ds_read_b64_tr_b16 v[24:25], v66
    ds_read_b64_tr_b16 v[26:27], v66 offset:256
    s_waitcnt lgkmcnt(0)
    buffer_store_dwordx4 v[24:27], v127, s[52:55], s73 offen sc0 sc1
Lnowo_21:
    s_cmp_eq_u32 s56, 1
    s_cbranch_scc1 Lc1_22
    s_and_b32 s71, s56, 6
    s_cmp_eq_u32 s71, 2
    s_cbranch_scc1 Lc2_23
    s_cmp_lg_u32 s70, 0
    s_cbranch_scc1 Lce_24
    v_cmp_eq_u32 vcc, v5, v8
    v_or_b32 v6, v2, v8
    v_cmp_eq_u32 s[86:87], 0, v6
    v_mov_b32 v6, 0x3f003f00
    v_mov_b32 v7, 0xbf003f00
    v_cndmask_b32 v76, 0, v76, vcc
    v_cndmask_b32 v80, 0, v80, vcc
    v_cndmask_b32 v76, v76, v6, s[86:87]
    v_cndmask_b32 v80, v80, v7, s[86:87]
    v_cndmask_b32 v77, 0, v77, vcc
    v_cndmask_b32 v81, 0, v81, vcc
    v_cndmask_b32 v77, v77, v6, s[86:87]
    v_cndmask_b32 v81, v81, v7, s[86:87]
    v_cndmask_b32 v78, 0, v78, vcc
    v_cndmask_b32 v82, 0, v82, vcc
    v_cndmask_b32 v78, v78, v6, s[86:87]
    v_cndmask_b32 v82, v82, v7, s[86:87]
    v_cndmask_b32 v79, 0, v79, vcc
    v_cndmask_b32 v83, 0, v83, vcc
    v_cndmask_b32 v79, v79, v6, s[86:87]
    v_cndmask_b32 v83, v83, v7, s[86:87]
    s_nop 0
    s_branch Lce_24
Lc1_22:
    v_lshrrev_b32 v10, 1, v2
    s_lshl_b32 s70, s58, 3
    v_add_u32 v4, s70, v10
    v_cvt_f32_u32 v6, v4
    v_mul_f32 v6, 0x3d000000, v6
    v_cvt_f32_u32 v7, v23
    v_mul_f32 v7, 0x3e800000, v7
    v_cmp_lt_u32 vcc, v4, v23
    v_lshlrev_b32 v8, 2, v3
    v_cvt_f32_u32 v8, v8
    v_cndmask_b32 v6, v6, 0.5, vcc
    v_cndmask_b32 v7, v7, 0, vcc
    v_fma_f32 v9, v8, v6, v7
    v_fmamk_f32 v36, v6, 0x00000000, v9
    v_fmamk_f32 v37, v6, 0x3f800000, v9
    v_fmamk_f32 v38, v6, 0x40000000, v9
    v_fmamk_f32 v39, v6, 0x40400000, v9
    v_fmamk_f32 v40, v6, 0x41800000, v9
    v_fmamk_f32 v41, v6, 0x41880000, v9
    v_fmamk_f32 v42, v6, 0x41900000, v9
    v_fmamk_f32 v43, v6, 0x41980000, v9
    v_cos_f32 v36, v36
    v_cos_f32 v37, v37
    v_cos_f32 v38, v38
    v_cos_f32 v39, v39
    v_cos_f32 v40, v40
    v_cos_f32 v41, v41
    v_cos_f32 v42, v42
    v_cos_f32 v43, v43
    v_mul_f32 v36, 0x36000000, v36
    v_mul_f32 v37, 0x36000000, v37
    v_mul_f32 v38, 0x36000000, v38
    v_mul_f32 v39, 0x36000000, v39
    v_mul_f32 v40, 0x36000000, v40
    v_mul_f32 v41, 0x36000000, v41
    v_mul_f32 v42, 0x36000000, v42
    v_mul_f32 v43, 0x36000000, v43
    v_cvt_pk_bf16_f32 v72, v36, v37
    v_cvt_pk_bf16_f32 v73, v38, v39
    v_cvt_pk_bf16_f32 v74, v40, v41
    v_cvt_pk_bf16_f32 v75, v42, v43
    ds_write_b128 v112, v[72:75] offset:20480
    s_branch Lce_24
Lc2_23:
    v_lshl_add_u32 v12, v3, 9, s57
    v_cvt_f32_u32 v12, v12
    v_mul_f32 v12, 0x3a000000, v12
    s_and_b32 s71, s56, 1
    s_lshl_b32 s70, s71, 4
    v_add_u32 v13, s70, v2
    v_cvt_f32_u32 v13, v13
    v_mul_f32 v15, v12, v13
    s_lshl_b32 s70, s71, 10
    v_add_u32 v14, s70, v112
    v_fmamk_f32 v36, v13, 0x00000000, v15
    v_fmamk_f32 v37, v13, 0x3d000000, v15
    v_fmamk_f32 v38, v13, 0x3d800000, v15
    v_fmamk_f32 v39, v13, 0x3dc00000, v15
    v_fmamk_f32 v40, v13, 0x3e000000, v15
    v_fmamk_f32 v41, v13, 0x3e200000, v15
    v_fmamk_f32 v42, v13, 0x3e400000, v15
    v_fmamk_f32 v43, v13, 0x3e600000, v15
    v_sin_f32 v44, v36
    v_cos_f32 v36, v36
    v_sin_f32 v45, v37
    v_cos_f32 v37, v37
    v_sin_f32 v46, v38
    v_cos_f32 v38, v38
    v_sin_f32 v47, v39
    v_cos_f32 v39, v39
    v_sin_f32 v48, v40
    v_cos_f32 v40, v40
    v_sin_f32 v49, v41
    v_cos_f32 v41, v41
    v_sin_f32 v50, v42
    v_cos_f32 v42, v42
    v_sin_f32 v51, v43
    v_cos_f32 v43, v43
    v_cvt_pk_bf16_f32 v84, v36, v37
    v_cvt_pk_bf16_f32 v85, v38, v39
    v_cvt_pk_bf16_f32 v86, v40, v41
    v_cvt_pk_bf16_f32 v87, v42, v43
    ds_write_b128 v14, v[84:87] offset:21504
    v_cvt_pk_bf16_f32 v88, v44, v45
    v_cvt_pk_bf16_f32 v89, v46, v47
    v_cvt_pk_bf16_f32 v90, v48, v49
    v_cvt_pk_bf16_f32 v91, v50, v51
    ds_write_b128 v14, v[88:91] offset:23552
    v_cvt_pk_bf16_f32 v92, -v44, -v45
    v_cvt_pk_bf16_f32 v93, -v46, -v47
    v_cvt_pk_bf16_f32 v94, -v48, -v49
    v_cvt_pk_bf16_f32 v95, -v50, -v51
    ds_write_b128 v14, v[92:95] offset:25600
Lce_24:
    s_mov_b64 s[48:49], s[16:17]
    s_mov_b32 s50, 4194304
    s_mov_b32 s51, 0x20000
    s_lshl_b32 s70, s56, 12
    v_lshl_add_u32 v60, v1, 3, s70
    v_xor_b32 v6, v3, v22
    v_lshlrev_b32 v6, 3, v6
    v_lshrrev_b32 v10, 1, v2
    v_mul_u32_u24 v10, 2112, v10
    v_lshl_add_u32 v6, v23, 5, v6
    s_lshl_b32 s70, s56, 8
    s_add_u32 s70, s70, 32768
    v_add3_u32 v61, v6, v10, s70
    v_lshlrev_b32 v56, 9, v22
    v_and_b32 v57, 3, v2
    v_lshl_add_u32 v56, v57, 6, v56
    v_lshl_add_u32 v56, v3, 4, v56
    s_mul_i32 s70, s56, 2112
    s_add_u32 s70, s70, 32768
    v_add_u32 v62, s70, v56
    s_cmp_lt_u32 s56, 4
    s_cbranch_scc1 Ltsel_25
    s_cmp_ge_u32 s56, 6
    s_cbranch_scc1 Ltsel_25
    s_lshr_b32 s70, s60, 1
    s_bitcmp1_b32 s60, 0
    s_cbranch_scc1 Ltw_26
    s_lshr_b32 s71, s59, 1
    s_lshl_b32 s71, s71, 3
    s_add_u32 s70, s70, s71
    s_lshl_b32 s70, s70, 16
    s_lshl_b32 s71, s56, 7
    s_add_u32 s70, s70, s71
    v_lshlrev_b32 v26, 10, v1
    buffer_load_dword v113, v26, s[36:39], s70 offen
    s_branch Ltx_27
Ltw_26:
    s_lshl_b32 s71, s56, 3
    s_add_u32 s70, s70, s71
    s_mul_i32 s70, s70, 24576
    s_and_b32 s71, s59, 1
    s_lshl_b32 s71, s71, 9
    s_add_u32 s70, s70, s71
    s_add_u32 s70, s70, 1024
    v_lshrrev_b32 v26, 3, v1
    v_mul_u32_u24 v26, 3072, v26
    v_bfe_u32 v27, v1, 2, 1
    v_lshl_add_u32 v26, v27, 10, v26
    v_and_b32 v27, 3, v1
    v_lshl_add_u32 v26, v27, 7, v26
    buffer_load_dword v113, v26, s[40:43], s70 offen
Ltx_27:
Ltsel_25:
    s_cmp_ge_u32 s56, 3
    s_cbranch_scc1 Ltq_28
    s_cmp_lt_u32 s56, 2
    s_cbranch_scc1 Ltq_28
    s_lshl_b32 s70, s56, 4
    s_add_u32 s70, s70, s60
    s_mul_i32 s70, s70, 24576
    s_and_b32 s71, s59, 1
    s_lshl_b32 s71, s71, 9
    s_add_u32 s70, s70, s71
    v_bfe_u32 v26, v1, 2, 3
    v_mul_u32_u24 v26, 3072, v26
    v_and_b32 v27, 3, v1
    v_lshl_add_u32 v26, v27, 7, v26
    buffer_load_dword v113, v26, s[40:43], s70 offen
Ltq_28:
    v_lshlrev_b32 v5, 2, v3
    v_cvt_f32_u32 v5, v5
    v_lshrrev_b32 v9, 5, v1
    v_cvt_f32_u32 v9, v9
    v_bfe_u32 v10, v1, 3, 2
    v_and_b32 v11, 3, v1
    v_lshl_add_u32 v10, v10, 2, v11
    v_cvt_f32_u32 v10, v10
    s_cmp_eq_u32 s56, 4
    s_cbranch_scc1 Lt0_29
    s_cmp_eq_u32 s56, 5
    s_cbranch_scc1 Lt1_30
    s_cmp_eq_u32 s56, 6
    s_cbranch_scc1 Lt2_31
    s_cmp_eq_u32 s56, 7
    s_cbranch_scc1 Lt3_32
    s_lshl_b32 s70, s56, 4
    v_add_u32 v4, s70, v2
    v_cvt_f32_u32 v4, v4
    v_mul_f32 v4, 0x3c800000, v4
    v_mul_f32 v6, v4, v5
    v_and_b32 v7, 1, v2
    v_mul_u32_u24 v7, 0x8000, v7
    v_lshl_or_b32 v7, v7, 16, v7
    v_fmamk_f32 v36, v4, 0x00000000, v6
    v_fmamk_f32 v37, v4, 0x3f800000, v6
    v_fmamk_f32 v38, v4, 0x40000000, v6
    v_fmamk_f32 v39, v4, 0x40400000, v6
    v_fmamk_f32 v40, v4, 0x41800000, v6
    v_fmamk_f32 v41, v4, 0x41880000, v6
    v_fmamk_f32 v42, v4, 0x41900000, v6
    v_fmamk_f32 v43, v4, 0x41980000, v6
    v_sin_f32 v44, v36
    v_cos_f32 v36, v36
    v_sin_f32 v45, v37
    v_cos_f32 v37, v37
    v_sin_f32 v46, v38
    v_cos_f32 v38, v38
    v_sin_f32 v47, v39
    v_cos_f32 v39, v39
    v_sin_f32 v48, v40
    v_cos_f32 v40, v40
    v_sin_f32 v49, v41
    v_cos_f32 v41, v41
    v_sin_f32 v50, v42
    v_cos_f32 v42, v42
    v_sin_f32 v51, v43
    v_cos_f32 v43, v43
    s_lshl_b32 s70, s56, 12
    v_add_u32 v8, s70, v112
    v_cvt_pk_bf16_f32 v52, v36, v37
    v_xor_b32 v56, v7, v52
    v_cvt_pk_bf16_f32 v53, v38, v39
    v_xor_b32 v57, v7, v53
    v_cvt_pk_bf16_f32 v54, v40, v41
    v_xor_b32 v58, v7, v54
    v_cvt_pk_bf16_f32 v55, v42, v43
    v_xor_b32 v59, v7, v55
    ds_write_b128 v8, v[52:55] offset:40960
    ds_write_b128 v8, v[56:59] offset:41984
    v_cvt_pk_bf16_f32 v52, v44, v45
    v_xor_b32 v56, v7, v52
    v_cvt_pk_bf16_f32 v53, v46, v47
    v_xor_b32 v57, v7, v53
    v_cvt_pk_bf16_f32 v54, v48, v49
    v_xor_b32 v58, v7, v54
    v_cvt_pk_bf16_f32 v55, v50, v51
    v_xor_b32 v59, v7, v55
    ds_write_b128 v8, v[52:55] offset:43008
    ds_write_b128 v8, v[56:59] offset:44032
    s_branch Lte_33
Lt0_29:
    v_and_b32 v4, 7, v1
    s_lshl_b32 s70, s58, 10
    s_add_u32 s70, s70, s57
    v_lshl_add_u32 v4, v4, 6, s70
    v_cvt_f32_u32 v4, v4
    v_mul_f32 v4, 0x3a000000, v4
    v_bfe_u32 v7, v1, 3, 1
    v_cvt_f32_u32 v7, v7
    v_mul_f32 v7, 0xbe800000, v7
    v_fma_f32 v6, v4, v5, v7
    v_fmamk_f32 v36, v4, 0x00000000, v6
    v_fmamk_f32 v37, v4, 0x3f800000, v6
    v_fmamk_f32 v38, v4, 0x40000000, v6
    v_fmamk_f32 v39, v4, 0x40400000, v6
    v_fmamk_f32 v40, v4, 0x41800000, v6
    v_fmamk_f32 v41, v4, 0x41880000, v6
    v_fmamk_f32 v42, v4, 0x41900000, v6
    v_fmamk_f32 v43, v4, 0x41980000, v6
    v_sin_f32 v44, v36
    v_cos_f32 v36, v36
    v_sin_f32 v45, v37
    v_cos_f32 v37, v37
    v_sin_f32 v46, v38
    v_cos_f32 v38, v38
    v_sin_f32 v47, v39
    v_cos_f32 v39, v39
    v_sin_f32 v48, v40
    v_cos_f32 v40, v40
    v_sin_f32 v49, v41
    v_cos_f32 v41, v41
    v_sin_f32 v50, v42
    v_cos_f32 v42, v42
    v_sin_f32 v51, v43
    v_cos_f32 v43, v43
    v_cvt_pk_bf16_f32 v52, v36, v37
    v_cvt_pk_bf16_f32 v56, -v44, -v45
    v_cvt_pk_bf16_f32 v53, v38, v39
    v_cvt_pk_bf16_f32 v57, -v46, -v47
    v_cvt_pk_bf16_f32 v54, v40, v41
    v_cvt_pk_bf16_f32 v58, -v48, -v49
    v_cvt_pk_bf16_f32 v55, v42, v43
    v_cvt_pk_bf16_f32 v59, -v50, -v51
    ds_write_b128 v112, v[52:55] offset:0
    ds_write_b128 v112, v[56:59] offset:1024
    v_add_f32 v4, 0x3e800000, v4
    v_fma_f32 v6, v4, v5, v7
    v_fmamk_f32 v36, v4, 0x00000000, v6
    v_fmamk_f32 v37, v4, 0x3f800000, v6
    v_fmamk_f32 v38, v4, 0x40000000, v6
    v_fmamk_f32 v39, v4, 0x40400000, v6
    v_fmamk_f32 v40, v4, 0x41800000, v6
    v_fmamk_f32 v41, v4, 0x41880000, v6
    v_fmamk_f32 v42, v4, 0x41900000, v6
    v_fmamk_f32 v43, v4, 0x41980000, v6
    v_sin_f32 v44, v36
    v_cos_f32 v36, v36
    v_sin_f32 v45, v37
    v_cos_f32 v37, v37
    v_sin_f32 v46, v38
    v_cos_f32 v38, v38
    v_sin_f32 v47, v39
    v_cos_f32 v39, v39
    v_sin_f32 v48, v40
    v_cos_f32 v40, v40
    v_sin_f32 v49, v41
    v_cos_f32 v41, v41
    v_sin_f32 v50, v42
    v_cos_f32 v42, v42
    v_sin_f32 v51, v43
    v_cos_f32 v43, v43
    v_cvt_pk_bf16_f32 v52, v36, v37
    v_cvt_pk_bf16_f32 v56, -v44, -v45
    v_cvt_pk_bf16_f32 v53, v38, v39
    v_cvt_pk_bf16_f32 v57, -v46, -v47
    v_cvt_pk_bf16_f32 v54, v40, v41
    v_cvt_pk_bf16_f32 v58, -v48, -v49
    v_cvt_pk_bf16_f32 v55, v42, v43
    v_cvt_pk_bf16_f32 v59, -v50, -v51
    ds_write_b128 v112, v[52:55] offset:2048
    ds_write_b128 v112, v[56:59] offset:3072
    s_branch Lte_33
Lt1_30:
    v_mul_f32 v4, 0x3d800000, v10
    v_mul_f32 v6, 0x3e800000, v9
    v_bfe_i32 v7, v1, 2, 1
    v_fmamk_f32 v36, v4, 0x00000000, v6
    v_fmamk_f32 v37, v4, 0x3f800000, v6
    v_fmamk_f32 v38, v4, 0x40000000, v6
    v_fmamk_f32 v39, v4, 0x40400000, v6
    v_fmamk_f32 v40, v4, 0x40800000, v6
    v_fmamk_f32 v41, v4, 0x40a00000, v6
    v_fmamk_f32 v42, v4, 0x40c00000, v6
    v_fmamk_f32 v43, v4, 0x40e00000, v6
    v_sin_f32 v44, v36
    v_cos_f32 v36, v36
    v_sin_f32 v45, v37
    v_cos_f32 v37, v37
    v_sin_f32 v46, v38
    v_cos_f32 v38, v38
    v_sin_f32 v47, v39
    v_cos_f32 v39, v39
    v_sin_f32 v48, v40
    v_cos_f32 v40, v40
    v_sin_f32 v49, v41
    v_cos_f32 v41, v41
    v_sin_f32 v50, v42
    v_cos_f32 v42, v42
    v_sin_f32 v51, v43
    v_cos_f32 v43, v43
    v_cvt_pk_bf16_f32 v52, v36, v37
    v_and_b32 v56, v7, v52
    v_xor_b32 v52, v56, v52
    v_cvt_pk_bf16_f32 v53, v38, v39
    v_and_b32 v57, v7, v53
    v_xor_b32 v53, v57, v53
    v_cvt_pk_bf16_f32 v54, v40, v41
    v_and_b32 v58, v7, v54
    v_xor_b32 v54, v58, v54
    v_cvt_pk_bf16_f32 v55, v42, v43
    v_and_b32 v59, v7, v55
    v_xor_b32 v55, v59, v55
    ds_write_b128 v112, v[52:55] offset:4096
    ds_write_b128 v112, v[56:59] offset:5120
    v_cvt_pk_bf16_f32 v52, v44, v45
    v_and_b32 v56, v7, v52
    v_xor_b32 v52, v56, v52
    v_cvt_pk_bf16_f32 v53, v46, v47
    v_and_b32 v57, v7, v53
    v_xor_b32 v53, v57, v53
    v_cvt_pk_bf16_f32 v54, v48, v49
    v_and_b32 v58, v7, v54
    v_xor_b32 v54, v58, v54
    v_cvt_pk_bf16_f32 v55, v50, v51
    v_and_b32 v59, v7, v55
    v_xor_b32 v55, v59, v55
    ds_write_b128 v112, v[52:55] offset:6144
    ds_write_b128 v112, v[56:59] offset:7168
    s_branch Lte_33
Lt2_31:
    v_and_b32 v4, 31, v1
    v_cvt_f32_u32 v4, v4
    v_mul_f32 v4, 0x3d000000, v4
    v_mul_f32 v6, 4.0, v9
    v_mul_f32 v6, v6, v4
    v_and_b32 v7, 1, v1
    v_mul_u32_u24 v7, 0x8000, v7
    v_lshl_or_b32 v7, v7, 16, v7
    v_fmamk_f32 v36, v4, 0x00000000, v6
    v_fmamk_f32 v37, v4, 0x3f800000, v6
    v_fmamk_f32 v38, v4, 0x40000000, v6
    v_fmamk_f32 v39, v4, 0x40400000, v6
    v_fmamk_f32 v40, v4, 0x41000000, v6
    v_fmamk_f32 v41, v4, 0x41100000, v6
    v_fmamk_f32 v42, v4, 0x41200000, v6
    v_fmamk_f32 v43, v4, 0x41300000, v6
    v_sin_f32 v44, v36
    v_cos_f32 v36, v36
    v_sin_f32 v45, v37
    v_cos_f32 v37, v37
    v_sin_f32 v46, v38
    v_cos_f32 v38, v38
    v_sin_f32 v47, v39
    v_cos_f32 v39, v39
    v_sin_f32 v48, v40
    v_cos_f32 v40, v40
    v_sin_f32 v49, v41
    v_cos_f32 v41, v41
    v_sin_f32 v50, v42
    v_cos_f32 v42, v42
    v_sin_f32 v51, v43
    v_cos_f32 v43, v43
    v_cvt_pk_bf16_f32 v52, v36, v37
    v_xor_b32 v56, v7, v52
    v_cvt_pk_bf16_f32 v53, v38, v39
    v_xor_b32 v57, v7, v53
    v_cvt_pk_bf16_f32 v54, v40, v41
    v_xor_b32 v58, v7, v54
    v_cvt_pk_bf16_f32 v55, v42, v43
    v_xor_b32 v59, v7, v55
    ds_write_b128 v112, v[52:55] offset:8192
    ds_write_b128 v112, v[56:59] offset:9216
    v_cvt_pk_bf16_f32 v52, -v44, -v45
    v_xor_b32 v56, v7, v52
    v_cvt_pk_bf16_f32 v53, -v46, -v47
    v_xor_b32 v57, v7, v53
    v_cvt_pk_bf16_f32 v54, -v48, -v49
    v_xor_b32 v58, v7, v54
    v_cvt_pk_bf16_f32 v55, -v50, -v51
    v_xor_b32 v59, v7, v55
    ds_write_b128 v112, v[52:55] offset:10240
    ds_write_b128 v112, v[56:59] offset:11264
    s_branch Lte_33
Lt3_32:
    v_mul_f32 v4, 0x3b000000, v10
    v_mul_f32 v6, 4.0, v9
    v_mul_f32 v6, v6, v4
    v_fmamk_f32 v36, v4, 0x00000000, v6
    v_fmamk_f32 v37, v4, 0x3f800000, v6
    v_fmamk_f32 v38, v4, 0x40000000, v6
    v_fmamk_f32 v39, v4, 0x40400000, v6
    v_fmamk_f32 v40, v4, 0x41000000, v6
    v_fmamk_f32 v41, v4, 0x41100000, v6
    v_fmamk_f32 v42, v4, 0x41200000, v6
    v_fmamk_f32 v43, v4, 0x41300000, v6
    v_sin_f32 v44, v36
    v_cos_f32 v36, v36
    v_sin_f32 v45, v37
    v_cos_f32 v37, v37
    v_sin_f32 v46, v38
    v_cos_f32 v38, v38
    v_sin_f32 v47, v39
    v_cos_f32 v39, v39
    v_sin_f32 v48, v40
    v_cos_f32 v40, v40
    v_sin_f32 v49, v41
    v_cos_f32 v41, v41
    v_sin_f32 v50, v42
    v_cos_f32 v42, v42
    v_sin_f32 v51, v43
    v_cos_f32 v43, v43
    ds_write_b128 v112, v[36:39] offset:12288
    ds_write_b128 v112, v[40:43] offset:13312
    ds_write_b128 v112, v[44:47] offset:16384
    ds_write_b128 v112, v[48:51] offset:17408
    v_fmamk_f32 v36, v4, 0x41800000, v6
    v_fmamk_f32 v37, v4, 0x41880000, v6
    v_fmamk_f32 v38, v4, 0x41900000, v6
    v_fmamk_f32 v39, v4, 0x41980000, v6
    v_fmamk_f32 v40, v4, 0x41c00000, v6
    v_fmamk_f32 v41, v4, 0x41c80000, v6
    v_fmamk_f32 v42, v4, 0x41d00000, v6
    v_fmamk_f32 v43, v4, 0x41d80000, v6
    v_sin_f32 v44, v36
    v_cos_f32 v36, v36
    v_sin_f32 v45, v37
    v_cos_f32 v37, v37
    v_sin_f32 v46, v38
    v_cos_f32 v38, v38
    v_sin_f32 v47, v39
    v_cos_f32 v39, v39
    v_sin_f32 v48, v40
    v_cos_f32 v40, v40
    v_sin_f32 v49, v41
    v_cos_f32 v41, v41
    v_sin_f32 v50, v42
    v_cos_f32 v42, v42
    v_sin_f32 v51, v43
    v_cos_f32 v43, v43
    ds_write_b128 v112, v[36:39] offset:14336
    ds_write_b128 v112, v[40:43] offset:15360
    ds_write_b128 v112, v[44:47] offset:18432
    ds_write_b128 v112, v[48:51] offset:19456
Lte_33:
    s_cmp_lt_u32 s56, 6
    s_cbranch_scc1 Ltsel_34
    s_cmp_ge_u32 s56, 8
    s_cbranch_scc1 Ltsel_34
    s_lshr_b32 s70, s60, 1
    s_bitcmp1_b32 s60, 0
    s_cbranch_scc1 Ltw_35
    s_lshr_b32 s71, s59, 1
    s_lshl_b32 s71, s71, 3
    s_add_u32 s70, s70, s71
    s_lshl_b32 s70, s70, 16
    s_lshl_b32 s71, s56, 7
    s_add_u32 s70, s70, s71
    v_lshlrev_b32 v26, 10, v1
    buffer_load_dword v113, v26, s[36:39], s70 offen
    s_branch Ltx_36
Ltw_35:
    s_lshl_b32 s71, s56, 3
    s_add_u32 s70, s70, s71
    s_mul_i32 s70, s70, 24576
    s_and_b32 s71, s59, 1
    s_lshl_b32 s71, s71, 9
    s_add_u32 s70, s70, s71
    s_add_u32 s70, s70, 1024
    v_lshrrev_b32 v26, 3, v1
    v_mul_u32_u24 v26, 3072, v26
    v_bfe_u32 v27, v1, 2, 1
    v_lshl_add_u32 v26, v27, 10, v26
    v_and_b32 v27, 3, v1
    v_lshl_add_u32 v26, v27, 7, v26
    buffer_load_dword v113, v26, s[40:43], s70 offen
Ltx_36:
Ltsel_34:
    s_cmp_ge_u32 s56, 4
    s_cbranch_scc1 Ltq_37
    s_cmp_lt_u32 s56, 3
    s_cbranch_scc1 Ltq_37
    s_lshl_b32 s70, s56, 4
    s_add_u32 s70, s70, s60
    s_mul_i32 s70, s70, 24576
    s_and_b32 s71, s59, 1
    s_lshl_b32 s71, s71, 9
    s_add_u32 s70, s70, s71
    v_bfe_u32 v26, v1, 2, 3
    v_mul_u32_u24 v26, 3072, v26
    v_and_b32 v27, 3, v1
    v_lshl_add_u32 v26, v27, 7, v26
    buffer_load_dword v113, v26, s[40:43], s70 offen
Ltq_37:
    s_waitcnt lgkmcnt(0)
    s_add_u32 s67, s67, 1
    s_and_b32 s66, s67, 0xff
    s_mul_i32 s66, s66, 0x01010101
    s_xor_b32 s66, s66, 0x8e592b00
    s_mov_b32 s3, 0x10000
    v_lshl_add_u32 v56, v3, 5, v2
    v_mul_u32_u24 v56, 80, v56
    s_mul_i32 s70, s88, 10240
    s_lshl_b32 s71, s63, 3
    s_add_u32 s70, s70, s71
    s_add_u32 s70, s70, 73728
    v_add_u32 v63, s70, v56
    v_mov_b32 v126, 0x00010001
    s_lshl_b32 s70, s63, 2
    s_lshr_b32 s70, s66, s70
    s_bfe_u32 s82, s70, 131072
    s_mul_i32 s82, s82, 0x8001
    s_bfe_u32 s83, s70, 131074
    s_mul_i32 s83, s83, 0x8001
    s_bfe_u32 s84, s70, 131088
    s_mul_i32 s84, s84, 0x8001
    s_bfe_u32 s85, s70, 131090
    s_mul_i32 s85, s85, 0x8001
    s_mul_i32 s70, s56, 2560
    s_add_u32 s70, s70, 73728
    v_add_u32 v64, s70, v117
    s_mul_i32 s70, s57, 37120
    s_lshl_b32 s71, s58, 14
    s_add_u32 s70, s70, s71
    s_lshl_b32 s71, s56, 11
    s_add_u32 s77, s70, s71
    v_and_b32 v4, 3, v1
    v_lshlrev_b32 v4, 3, v4
    v_lshrrev_b32_e64 v4, v4, s66
    v_mov_b32 v126, 0x00010001
    v_bfe_u32 v122, v4, 0, 2
    v_mul_u32_u24 v122, 0x8001, v122
    v_bfe_u32 v123, v4, 2, 2
    v_mul_u32_u24 v123, 0x8001, v123
    v_bfe_u32 v124, v4, 4, 2
    v_mul_u32_u24 v124, 0x8001, v124
    v_bfe_u32 v125, v4, 6, 2
    v_mul_u32_u24 v125, 0x8001, v125
    v_lshrrev_b32_e64 v4, v2, s66
    v_bfe_i32 v120, v4, 0, 1
    v_bfe_i32 v121, v4, 16, 1
    v_lshrrev_b32 v4, 2, v1
    v_lshlrev_b32 v5, 6, v4
    v_lshl_add_u32 v5, v11, 3, v5
    v_and_b32 v6, 1, v3
    v_lshl_add_u32 v118, v6, 5, v5
    v_xor_b32 v119, 32, v118
    s_waitcnt vmcnt(2)
    s_cmp_ge_u32 s56, 2
    s_cbranch_scc1 Lxtw_38
    s_waitcnt vmcnt(1)
Lxtw_38:
    ds_read_b64_tr_b16 v[4:5], v60 offset:0
    ds_read_b64_tr_b16 v[6:7], v60 offset:512
    ds_read_b64_tr_b16 v[8:9], v60 offset:1024
    ds_read_b64_tr_b16 v[10:11], v60 offset:1536
    ds_read_b64_tr_b16 v[12:13], v60 offset:2048
    ds_read_b64_tr_b16 v[14:15], v60 offset:2560
    ds_read_b64_tr_b16 v[16:17], v60 offset:3072
    ds_read_b64_tr_b16 v[18:19], v60 offset:3584
    s_waitcnt lgkmcnt(8)
    s_barrier
    ds_read_b128 v[72:75], v112 offset:20480
    ds_read_b128 v[84:87], v112 offset:21504
    ds_read_b128 v[88:91], v112 offset:22528
    ds_read_b128 v[92:95], v112 offset:23552
    ds_read_b128 v[96:99], v112 offset:24576
    ds_read_b128 v[100:103], v112 offset:25600
    ds_read_b128 v[104:107], v112 offset:26624
    s_waitcnt lgkmcnt(6)
    v_mfma_f32_16x16x32_bf16 v[28:31], v[4:7], v[72:75], 0
    v_mfma_f32_16x16x32_bf16 v[32:35], v[8:11], v[72:75], 0
    v_mfma_f32_16x16x32_bf16 v[68:71], v[12:15], v[72:75], 0
    v_mfma_f32_16x16x32_bf16 v[108:111], v[16:19], v[72:75], 0
    s_nop 4
    v_cvt_pk_bf16_f32 v4, v28, v29
    v_cvt_pk_bf16_f32 v5, v30, v31
    ds_write_b64 v61, v[4:5] offset:0
    v_cvt_pk_bf16_f32 v6, v32, v33
    v_cvt_pk_bf16_f32 v7, v34, v35
    ds_write_b64 v61, v[6:7] offset:64
    v_cvt_pk_bf16_f32 v8, v68, v69
    v_cvt_pk_bf16_f32 v9, v70, v71
    ds_write_b64 v61, v[8:9] offset:128
    v_cvt_pk_bf16_f32 v10, v108, v109
    v_cvt_pk_bf16_f32 v11, v110, v111
    ds_write_b64 v61, v[10:11] offset:192
    s_waitcnt lgkmcnt(0)
    s_barrier
    ds_read_b128 v[4:7], v62
    ds_read_b128 v[8:11], v62 offset:256
    s_waitcnt lgkmcnt(1)
    v_mfma_f32_16x16x32_bf16 v[12:15], v[4:7], v[76:79], 0
    v_mfma_f32_16x16x32_bf16 v[20:23], v[4:7], v[80:83], 0
    s_waitcnt lgkmcnt(0)
    v_mfma_f32_16x16x32_bf16 v[16:19], v[8:11], v[76:79], 0
    v_mfma_f32_16x16x32_bf16 v[24:27], v[8:11], v[80:83], 0
    s_nop 3
    v_cvt_pk_bf16_f32 v28, v12, v13
    v_cvt_pk_bf16_f32 v29, v14, v15
    v_cvt_pk_bf16_f32 v32, v20, v21
    v_cvt_pk_bf16_f32 v33, v22, v23
    v_cvt_pk_bf16_f32 v30, v16, v17
    v_cvt_pk_bf16_f32 v31, v18, v19
    v_cvt_pk_bf16_f32 v34, v24, v25
    v_cvt_pk_bf16_f32 v35, v26, v27
    s_cmp_ge_u32 s56, 4
    s_cbranch_scc1 Lcs_39
    ds_read_b128 a[0:3], v112 offset:40960
    ds_read_b128 a[4:7], v112 offset:41984
    ds_read_b128 a[32:35], v112 offset:43008
    ds_read_b128 a[36:39], v112 offset:44032
    ds_read_b128 a[8:11], v112 offset:45056
    ds_read_b128 a[12:15], v112 offset:46080
    ds_read_b128 a[40:43], v112 offset:47104
    ds_read_b128 a[44:47], v112 offset:48128
    ds_read_b128 a[16:19], v112 offset:49152
    ds_read_b128 a[20:23], v112 offset:50176
    ds_read_b128 a[48:51], v112 offset:51200
    ds_read_b128 a[52:55], v112 offset:52224
    ds_read_b128 a[24:27], v112 offset:53248
    ds_read_b128 a[28:31], v112 offset:54272
    ds_read_b128 a[56:59], v112 offset:55296
    ds_read_b128 a[60:63], v112 offset:56320
Lcs_39:
    s_add_u32 s70, s58, s56
    s_cmp_lg_u32 s70, 0
    s_cbranch_scc1 Lnox_40
    v_cmp_ne_u32 vcc, 0, v2
    v_mov_b32 v68, v32
    s_nop 0
    v_cndmask_b32 v32, 0, v32, vcc
    v_mov_b32 v69, v33
    v_cndmask_b32 v33, 0, v33, vcc
    v_mov_b32 v70, v34
    v_cndmask_b32 v34, 0, v34, vcc
    v_mov_b32 v71, v35
    v_cndmask_b32 v35, 0, v35, vcc
Lnox_40:
    v_mfma_f32_16x16x32_bf16 v[36:39], v[28:31], v[84:87], 0
    s_nop 0
    v_mfma_f32_16x16x32_bf16 v[40:43], v[32:35], v[84:87], 0
    v_mfma_f32_16x16x32_bf16 v[36:39], v[32:35], v[92:95], v[36:39]
    v_mfma_f32_16x16x32_bf16 v[40:43], v[28:31], v[100:103], v[40:43]
    v_mfma_f32_16x16x32_bf16 v[44:47], v[28:31], v[88:91], 0
    v_mfma_f32_16x16x32_bf16 v[48:51], v[32:35], v[88:91], 0
    v_mfma_f32_16x16x32_bf16 v[44:47], v[32:35], v[96:99], v[44:47]
    v_mfma_f32_16x16x32_bf16 v[48:51], v[28:31], v[104:107], v[48:51]
    s_nop 2
    v_cvt_pk_bf16_f32 v4, v36, v37
    v_cvt_pk_bf16_f32 v5, v38, v39
    v_bfi_b32 v4, v126, s82, v4
    v_bfi_b32 v5, v126, s83, v5
    ds_write_b64 v63, v[4:5] offset:0
    v_cvt_pk_bf16_f32 v6, v40, v41
    v_cvt_pk_bf16_f32 v7, v42, v43
    v_bfi_b32 v6, v126, s84, v6
    v_bfi_b32 v7, v126, s85, v7
    ds_write_b64 v63, v[6:7] offset:32
    v_cvt_pk_bf16_f32 v8, v44, v45
    v_cvt_pk_bf16_f32 v9, v46, v47
    v_bfi_b32 v8, v126, s82, v8
    v_bfi_b32 v9, v126, s83, v9
    ds_write_b64 v63, v[8:9] offset:1280
    v_cvt_pk_bf16_f32 v10, v48, v49
    v_cvt_pk_bf16_f32 v11, v50, v51
    v_bfi_b32 v10, v126, s84, v10
    v_bfi_b32 v11, v126, s85, v11
    ds_write_b64 v63, v[10:11] offset:1312
    s_cmp_lt_u32 s56, 4
    s_cbranch_scc1 Lnowait_41
    s_waitcnt vmcnt(1)
Lnowait_41:
    s_waitcnt lgkmcnt(0)
    s_barrier
    ds_read_b128 v[12:15], v64
    ds_read_b128 v[16:19], v64 offset:1280
    s_waitcnt lgkmcnt(1)
    buffer_store_dwordx4 v[12:15], v127, s[52:55], s77 offen sc0 sc1
    s_waitcnt lgkmcnt(0)
    buffer_store_dwordx4 v[16:19], v127, s[52:55], s77 offen offset:1024 sc0 sc1
    s_cmp_lg_u32 s56, 5
    s_cbranch_scc1 Lnoflag_42
    s_lshr_b32 s70, s65, 2
    s_lshl_b32 s70, s70, 7
    s_add_u32 s70, s70, 5439488
    v_lshlrev_b32 v22, 2, v1
    v_mov_b32 v23, s66
    s_mov_b32 exec_hi, 0
    buffer_store_dword v23, v22, s[52:55], s70 offen sc0 sc1
    s_mov_b64 exec, -1
Lnoflag_42:
    s_add_u32 s70, s58, s56
    s_cmp_lg_u32 s70, 0
    s_cbranch_scc1 Lnox_43
    v_mfma_f32_16x16x32_bf16 v[36:39], v[68:71], v[84:87], 0
    v_mfma_f32_16x16x32_bf16 v[40:43], v[68:71], v[100:103], 0
    v_mfma_f32_16x16x32_bf16 v[44:47], v[68:71], v[88:91], 0
    v_mfma_f32_16x16x32_bf16 v[48:51], v[68:71], v[104:107], 0
    s_lshl_b32 s70, s57, 8
    s_add_u32 s70, s70, 5242880
    v_lshlrev_b32 v56, 3, v1
    v_mov_b32 v53, s66
    v_mov_b32 v55, s66
    s_nop 0
    v_cvt_pk_bf16_f32 v52, v36, v40
    s_nop 0
    v_cvt_pk_bf16_f32 v54, v44, v48
    s_mov_b64 exec, 0xffff
    buffer_store_dwordx2 v[52:53], v56, s[52:55], s70 offen sc0 sc1
    buffer_store_dwordx2 v[54:55], v56, s[52:55], s70 offen offset:128 sc0 sc1
    s_mov_b64 exec, -1
Lnox_43:
    v_lshrrev_b32 v5, 3, v1
    v_mul_u32_u24 v5, 16448, v5
    v_and_b32 v6, 7, v1
    v_lshl_add_u32 v5, v6, 4, v5
    s_mul_i32 s70, s61, 514
    s_lshl_b32 s71, s62, 7
    s_add_u32 s69, s70, s71
    s_mul_i32 s71, s63, 263168
    s_add_u32 s69, s69, s71
    s_lshl_b32 s71, s56, 11
    s_add_u32 m0, s71, 110592
    s_cmp_ge_u32 s56, 4
    s_cbranch_scc1 Lwi_44
    buffer_load_dwordx4 v5, s[28:31], s69 offen nt lds
    s_add_u32 s69, s69, 130560
    buffer_load_dwordx4 v5, s[28:31], s69 offen offset:1024 nt lds
    s_branch Lwj_45
Lwi_44:
    buffer_load_dwordx4 v5, s[32:35], s69 offen nt lds
    s_add_u32 s69, s69, 130560
    buffer_load_dwordx4 v5, s[32:35], s69 offen offset:1024 nt lds
Lwj_45:
    s_cmp_eq_u32 s56, s76
    s_cbranch_scc0 Lew_46
    v_mul_u32_u24 v5, 16448, v1
    s_mul_i32 s70, s61, 514
    s_add_u32 s70, s70, 512
    buffer_load_ushort v115, v5, s[28:31], s70 offen
    buffer_load_ushort v116, v5, s[32:35], s70 offen
Lew_46:
    v_lshrrev_b32 v4, 2, v1
    v_and_b32 v11, 3, v1
    v_and_b32 v6, 1, v3
    v_lshlrev_b32 v6, 1, v6
    v_xor_b32 v6, v6, v11
    v_lshlrev_b32 v6, 4, v6
    v_mul_u32_u24 v4, 37120, v4
    v_add_u32 v96, v4, v6
    s_mul_i32 s72, s56, 5120
    v_add_u32 v97, s72, v118
    v_add_u32 v98, s72, v119
    s_lshl_b32 s70, s63, 2
    s_lshl_b32 s77, s63, 13
    s_lshl_b32 s71, s62, 11
    s_add_u32 s77, s77, s71
    s_lshl_b32 s71, s61, 6
    s_add_u32 s77, s77, s71
    v_bfe_u32 v5, v1, 2, 2
    v_add_u32 v5, s70, v5
    v_sub_u32 v6, 32, v5
    v_cmp_eq_u32 vcc, 0, v5
    v_bfe_u32 v7, v1, 1, 1
    s_nop 0
    v_cndmask_b32 v6, v6, 16, vcc
    v_cmp_eq_u32 vcc, 1, v7
    v_and_b32 v7, 1, v1
    s_nop 0
    v_cndmask_b32 v5, v5, v6, vcc
    v_lshl_add_u32 v5, v7, 5, v5
    v_lshlrev_b32 v5, 1, v5
    v_lshl_add_u32 v5, v3, 9, v5
    v_add_u32 v99, 110592, v5
    s_lshl_b32 s70, s56, 2
    v_mov_b32 v5, s70
    v_mov_b32 v6, 0
    ds_write_b32 v5, v6 offset:52288
    s_mov_b32 s68, 1000000
    s_cmp_ge_u32 s56, 4
    s_cbranch_scc1 Lhi_47
    s_sleep 30
    s_add_u32 m0, s72, 0
    s_add_u32 s69, s77, 0
    buffer_load_dwordx4 v96, s[52:55], s69 offen sc0 sc1 lds
    s_add_u32 s69, s69, 592896
    buffer_load_dwordx4 v96, s[52:55], s69 offen offset:1024 sc0 sc1 lds
    s_add_u32 m0, s72, 2048
    s_add_u32 s69, s77, 1187840
    buffer_load_dwordx4 v96, s[52:55], s69 offen sc0 sc1 lds
    s_add_u32 s69, s69, 592896
    buffer_load_dwordx4 v96, s[52:55], s69 offen offset:1024 sc0 sc1 lds
    s_waitcnt vmcnt(2)
Lxc_51:
    ds_read_b64_tr_b16 v[36:37], v97 offset:0
    ds_read_b64_tr_b16 v[38:39], v97 offset:1024
    ds_read_b64_tr_b16 v[44:45], v98 offset:0
    ds_read_b64_tr_b16 v[46:47], v98 offset:1024
    s_waitcnt lgkmcnt(2)
    v_xor_b32 v6, v36, v120
    v_bitop3_b32 v6, v6, v37, v120 bitop3:0xf6
    v_bitop3_b32 v6, v6, v38, v120 bitop3:0xf6
    v_bitop3_b32 v6, v6, v39, v120 bitop3:0xf6
    s_waitcnt lgkmcnt(0)
    v_bitop3_b32 v6, v6, v44, v121 bitop3:0xf6
    v_bitop3_b32 v6, v6, v45, v121 bitop3:0xf6
    v_bitop3_b32 v6, v6, v46, v121 bitop3:0xf6
    v_bitop3_b32 v6, v6, v47, v121 bitop3:0xf6
    v_and_b32 v6, v126, v6
    v_cmp_ne_u32 vcc, 0, v6
    s_nop 3
    s_cbranch_vccnz Lrt_52
Lrk_53:
    v_bfi_b32 v36, v126, s3, v36
    v_bfi_b32 v44, v126, s3, v44
    v_bfi_b32 v37, v126, s3, v37
    v_bfi_b32 v45, v126, s3, v45
    v_bfi_b32 v38, v126, s3, v38
    v_bfi_b32 v46, v126, s3, v46
    v_bfi_b32 v39, v126, s3, v39
    v_bfi_b32 v47, v126, s3, v47
    s_waitcnt vmcnt(0)
Lxc_54:
    ds_read_b64_tr_b16 v[40:41], v97 offset:2048
    ds_read_b64_tr_b16 v[42:43], v97 offset:3072
    ds_read_b64_tr_b16 v[48:49], v98 offset:2048
    ds_read_b64_tr_b16 v[50:51], v98 offset:3072
    s_waitcnt lgkmcnt(2)
    v_xor_b32 v6, v40, v120
    v_bitop3_b32 v6, v6, v41, v120 bitop3:0xf6
    v_bitop3_b32 v6, v6, v42, v120 bitop3:0xf6
    v_bitop3_b32 v6, v6, v43, v120 bitop3:0xf6
    s_waitcnt lgkmcnt(0)
    v_bitop3_b32 v6, v6, v48, v121 bitop3:0xf6
    v_bitop3_b32 v6, v6, v49, v121 bitop3:0xf6
    v_bitop3_b32 v6, v6, v50, v121 bitop3:0xf6
    v_bitop3_b32 v6, v6, v51, v121 bitop3:0xf6
    v_and_b32 v6, v126, v6
    v_cmp_ne_u32 vcc, 0, v6
    s_nop 3
    s_cbranch_vccnz Lrt_55
Lrk_56:
    s_barrier
    s_setprio 2
    ds_read_u16_d16_hi v60, v99 offset:0
    ds_read_u16_d16_hi v61, v99 offset:128
    ds_read_u16_d16_hi v62, v99 offset:256
    ds_read_u16_d16_hi v63, v99 offset:384
    v_mfma_f32_16x16x32_bf16 v[4:7], a[0:3], v[36:39], 0
    v_bfi_b32 v40, v126, s3, v40
    v_bfi_b32 v41, v126, s3, v41
    v_bfi_b32 v42, v126, s3, v42
    v_bfi_b32 v43, v126, s3, v43
    v_mfma_f32_16x16x32_bf16 v[20:23], a[0:3], v[44:47], 0
    v_bfi_b32 v48, v126, s3, v48
    v_bfi_b32 v49, v126, s3, v49
    v_bfi_b32 v50, v126, s3, v50
    v_bfi_b32 v51, v126, s3, v51
    v_mfma_f32_16x16x32_bf16 v[4:7], a[4:7], v[40:43], v[4:7]
    v_xor_b32 v52, 0x80008000, v36
    v_xor_b32 v53, 0x80008000, v37
    ds_read_u16_d16_hi v76, v99 offset:8192
    ds_read_u16_d16_hi v77, v99 offset:8320
    v_mfma_f32_16x16x32_bf16 v[20:23], a[4:7], v[48:51], v[20:23]
    v_xor_b32 v54, 0x80008000, v38
    v_xor_b32 v55, 0x80008000, v39
    ds_read_u16_d16_hi v78, v99 offset:8448
    ds_read_u16_d16_hi v79, v99 offset:8576
    v_mfma_f32_16x16x32_bf16 v[4:7], a[32:35], v[44:47], v[4:7]
    v_xor_b32 v56, 0x80008000, v40
    v_xor_b32 v57, 0x80008000, v41
    ds_read_u16_d16_hi v64, v99 offset:2048
    ds_read_u16_d16_hi v65, v99 offset:2176
    v_mfma_f32_16x16x32_bf16 v[20:23], a[32:35], v[52:55], v[20:23]
    v_xor_b32 v58, 0x80008000, v42
    v_xor_b32 v59, 0x80008000, v43
    ds_read_u16_d16_hi v66, v99 offset:2304
    ds_read_u16_d16_hi v67, v99 offset:2432
    v_mfma_f32_16x16x32_bf16 v[4:7], a[36:39], v[48:51], v[4:7]
    ds_read_u16_d16_hi v80, v99 offset:10240
    ds_read_u16_d16_hi v81, v99 offset:10368
    v_mfma_f32_16x16x32_bf16 v[20:23], a[36:39], v[56:59], v[20:23]
    ds_read_u16_d16_hi v82, v99 offset:10496
    ds_read_u16_d16_hi v83, v99 offset:10624
    v_mfma_f32_16x16x32_bf16 v[8:11], a[8:11], v[36:39], 0
    ds_read_u16_d16_hi v68, v99 offset:4096
    ds_read_u16_d16_hi v69, v99 offset:4224
    v_mfma_f32_16x16x32_bf16 v[24:27], a[8:11], v[44:47], 0
    ds_read_u16_d16_hi v70, v99 offset:4352
    ds_read_u16_d16_hi v71, v99 offset:4480
    v_mfma_f32_16x16x32_bf16 v[8:11], a[12:15], v[40:43], v[8:11]
    ds_read_u16_d16_hi v84, v99 offset:12288
    ds_read_u16_d16_hi v85, v99 offset:12416
    v_mfma_f32_16x16x32_bf16 v[24:27], a[12:15], v[48:51], v[24:27]
    ds_read_u16_d16_hi v86, v99 offset:12544
    ds_read_u16_d16_hi v87, v99 offset:12672
    v_mfma_f32_16x16x32_bf16 v[8:11], a[40:43], v[44:47], v[8:11]
    ds_read_u16_d16_hi v72, v99 offset:6144
    ds_read_u16_d16_hi v73, v99 offset:6272
    v_mfma_f32_16x16x32_bf16 v[24:27], a[40:43], v[52:55], v[24:27]
    ds_read_u16_d16_hi v74, v99 offset:6400
    ds_read_u16_d16_hi v75, v99 offset:6528
    v_mfma_f32_16x16x32_bf16 v[8:11], a[44:47], v[48:51], v[8:11]
    ds_read_u16_d16_hi v88, v99 offset:14336
    ds_read_u16_d16_hi v89, v99 offset:14464
    v_mfma_f32_16x16x32_bf16 v[24:27], a[44:47], v[56:59], v[24:27]
    ds_read_u16_d16_hi v90, v99 offset:14592
    ds_read_u16_d16_hi v91, v99 offset:14720
    s_waitcnt lgkmcnt(15)
    v_mfma_f32_16x16x32_bf16 v[12:15], a[16:19], v[36:39], 0
    v_pk_mul_f32 v[92:93], v[20:21], v[76:77]
    v_pk_mul_f32 v[94:95], v[20:21], v[60:61]
    v_mfma_f32_16x16x32_bf16 v[28:31], a[16:19], v[44:47], 0
    v_pk_fma_f32 v[20:21], v[4:5], v[76:77], v[94:95]
    v_pk_fma_f32 v[4:5], v[4:5], v[60:61], v[92:93] neg_lo:[0,0,1] neg_hi:[0,0,1]
    v_mfma_f32_16x16x32_bf16 v[12:15], a[20:23], v[40:43], v[12:15]
    v_cvt_pk_bf16_f32 v104, v20, v21
    v_cvt_pk_bf16_f32 v100, v4, v5
    v_mfma_f32_16x16x32_bf16 v[28:31], a[20:23], v[48:51], v[28:31]
    v_cvt_pk_bf16_f32 v108, -v20, -v21
    v_pk_mul_f32 v[92:93], v[22:23], v[78:79]
    v_mfma_f32_16x16x32_bf16 v[12:15], a[48:51], v[44:47], v[12:15]
    v_pk_mul_f32 v[94:95], v[22:23], v[62:63]
    v_pk_fma_f32 v[22:23], v[6:7], v[78:79], v[94:95]
    v_mfma_f32_16x16x32_bf16 v[28:31], a[48:51], v[52:55], v[28:31]
    v_pk_fma_f32 v[6:7], v[6:7], v[62:63], v[92:93] neg_lo:[0,0,1] neg_hi:[0,0,1]
    v_cvt_pk_bf16_f32 v105, v22, v23
    v_mfma_f32_16x16x32_bf16 v[12:15], a[52:55], v[48:51], v[12:15]
    v_cvt_pk_bf16_f32 v101, v6, v7
    v_cvt_pk_bf16_f32 v109, -v22, -v23
    v_mfma_f32_16x16x32_bf16 v[28:31], a[52:55], v[56:59], v[28:31]
    s_waitcnt lgkmcnt(0)
    v_mfma_f32_16x16x32_bf16 v[16:19], a[24:27], v[36:39], 0
    v_pk_mul_f32 v[92:93], v[24:25], v[80:81]
    v_pk_mul_f32 v[94:95], v[24:25], v[64:65]
    v_mfma_f32_16x16x32_bf16 v[32:35], a[24:27], v[44:47], 0
    v_pk_fma_f32 v[24:25], v[8:9], v[80:81], v[94:95]
    v_pk_fma_f32 v[8:9], v[8:9], v[64:65], v[92:93] neg_lo:[0,0,1] neg_hi:[0,0,1]
    v_mfma_f32_16x16x32_bf16 v[16:19], a[28:31], v[40:43], v[16:19]
    v_cvt_pk_bf16_f32 v106, v24, v25
    v_cvt_pk_bf16_f32 v102, v8, v9
    v_mfma_f32_16x16x32_bf16 v[32:35], a[28:31], v[48:51], v[32:35]
    v_cvt_pk_bf16_f32 v110, -v24, -v25
    v_pk_mul_f32 v[92:93], v[26:27], v[82:83]
    v_mfma_f32_16x16x32_bf16 v[16:19], a[56:59], v[44:47], v[16:19]
    v_pk_mul_f32 v[94:95], v[26:27], v[66:67]
    v_pk_fma_f32 v[26:27], v[10:11], v[82:83], v[94:95]
    v_mfma_f32_16x16x32_bf16 v[32:35], a[56:59], v[52:55], v[32:35]
    v_pk_fma_f32 v[10:11], v[10:11], v[66:67], v[92:93] neg_lo:[0,0,1] neg_hi:[0,0,1]
    v_cvt_pk_bf16_f32 v107, v26, v27
    v_mfma_f32_16x16x32_bf16 v[16:19], a[60:63], v[48:51], v[16:19]
    v_cvt_pk_bf16_f32 v103, v10, v11
    v_cvt_pk_bf16_f32 v111, -v26, -v27
    v_mfma_f32_16x16x32_bf16 v[32:35], a[60:63], v[56:59], v[32:35]
    v_mfma_f32_16x16x32_bf16 v[4:7], v[100:103], a[0:3], 0
    v_pk_mul_f32 v[92:93], v[28:29], v[84:85]
    v_pk_mul_f32 v[94:95], v[28:29], v[68:69]
    v_mfma_f32_16x16x32_bf16 v[20:23], v[104:107], a[0:3], 0
    v_pk_fma_f32 v[28:29], v[12:13], v[84:85], v[94:95]
    v_pk_fma_f32 v[12:13], v[12:13], v[68:69], v[92:93] neg_lo:[0,0,1] neg_hi:[0,0,1]
    v_mfma_f32_16x16x32_bf16 v[4:7], v[108:111], a[32:35], v[4:7]
    v_cvt_pk_bf16_f32 v48, v28, v29
    v_cvt_pk_bf16_f32 v40, v12, v13
    v_mfma_f32_16x16x32_bf16 v[20:23], v[100:103], a[32:35], v[20:23]
    v_cvt_pk_bf16_f32 v56, -v28, -v29
    v_pk_mul_f32 v[92:93], v[30:31], v[86:87]
    v_mfma_f32_16x16x32_bf16 v[8:11], v[100:103], a[8:11], 0
    v_pk_mul_f32 v[94:95], v[30:31], v[70:71]
    v_pk_fma_f32 v[30:31], v[14:15], v[86:87], v[94:95]
    v_mfma_f32_16x16x32_bf16 v[24:27], v[104:107], a[8:11], 0
    v_pk_fma_f32 v[14:15], v[14:15], v[70:71], v[92:93] neg_lo:[0,0,1] neg_hi:[0,0,1]
    v_cvt_pk_bf16_f32 v49, v30, v31
    v_mfma_f32_16x16x32_bf16 v[8:11], v[108:111], a[40:43], v[8:11]
    v_cvt_pk_bf16_f32 v41, v14, v15
    v_cvt_pk_bf16_f32 v57, -v30, -v31
    v_mfma_f32_16x16x32_bf16 v[24:27], v[100:103], a[40:43], v[24:27]
    v_pk_mul_f32 v[92:93], v[32:33], v[88:89]
    v_pk_mul_f32 v[94:95], v[32:33], v[72:73]
    v_mfma_f32_16x16x32_bf16 v[60:63], v[100:103], a[16:19], 0
    v_pk_fma_f32 v[32:33], v[16:17], v[88:89], v[94:95]
    v_pk_fma_f32 v[16:17], v[16:17], v[72:73], v[92:93] neg_lo:[0,0,1] neg_hi:[0,0,1]
    v_mfma_f32_16x16x32_bf16 v[76:79], v[104:107], a[16:19], 0
    v_cvt_pk_bf16_f32 v50, v32, v33
    v_cvt_pk_bf16_f32 v42, v16, v17
    v_mfma_f32_16x16x32_bf16 v[60:63], v[108:111], a[48:51], v[60:63]
    v_cvt_pk_bf16_f32 v58, -v32, -v33
    v_pk_mul_f32 v[92:93], v[34:35], v[90:91]
    v_mfma_f32_16x16x32_bf16 v[76:79], v[100:103], a[48:51], v[76:79]
    v_pk_mul_f32 v[94:95], v[34:35], v[74:75]
    v_pk_fma_f32 v[34:35], v[18:19], v[90:91], v[94:95]
    v_mfma_f32_16x16x32_bf16 v[64:67], v[100:103], a[24:27], 0
    v_pk_fma_f32 v[18:19], v[18:19], v[74:75], v[92:93] neg_lo:[0,0,1] neg_hi:[0,0,1]
    v_cvt_pk_bf16_f32 v51, v34, v35
    v_mfma_f32_16x16x32_bf16 v[80:83], v[104:107], a[24:27], 0
    v_cvt_pk_bf16_f32 v43, v18, v19
    v_cvt_pk_bf16_f32 v59, -v34, -v35
    v_mfma_f32_16x16x32_bf16 v[64:67], v[108:111], a[56:59], v[64:67]
    v_mfma_f32_16x16x32_bf16 v[80:83], v[100:103], a[56:59], v[80:83]
    v_mfma_f32_16x16x32_bf16 v[4:7], v[40:43], a[4:7], v[4:7]
    v_lshlrev_b32 v15, 2, v3
    v_lshrrev_b32_e64 v15, v15, s66
    v_bfe_u32 v16, v15, 0, 2
    v_mul_u32_u24 v16, 0x8001, v16
    v_bfe_u32 v17, v15, 2, 2
    v_mfma_f32_16x16x32_bf16 v[20:23], v[48:51], a[4:7], v[20:23]
    v_mul_u32_u24 v17, 0x8001, v17
    v_bfe_u32 v18, v15, 16, 2
    v_mul_u32_u24 v18, 0x8001, v18
    v_bfe_u32 v19, v15, 18, 2
    v_mul_u32_u24 v19, 0x8001, v19
    v_mfma_f32_16x16x32_bf16 v[4:7], v[56:59], a[36:39], v[4:7]
    s_lshr_b32 s70, s56, 1
    s_and_b32 s71, s56, 1
    s_mul_i32 s73, s70, 9216
    s_add_u32 s73, s73, 73728
    v_mul_u32_u24 v12, 144, v2
    v_mfma_f32_16x16x32_bf16 v[20:23], v[40:43], a[36:39], v[20:23]
    v_lshl_add_u32 v12, v3, 3, v12
    s_lshl_b32 s74, s71, 6
    s_add_u32 s74, s74, s73
    v_add_u32 v12, s74, v12
    v_lshrrev_b32 v15, 3, v1
    v_mfma_f32_16x16x32_bf16 v[8:11], v[40:43], a[12:15], v[8:11]
    v_mul_u32_u24 v13, 144, v15
    v_mul_u32_u24 v14, 37120, v15
    v_and_b32 v15, 7, v1
    v_lshl_add_u32 v13, v15, 4, v13
    v_lshl_add_u32 v14, v15, 4, v14
    v_mfma_f32_16x16x32_bf16 v[24:27], v[48:51], a[12:15], v[24:27]
    s_mul_i32 s74, s71, 4608
    s_add_u32 s74, s74, s73
    v_add_u32 v13, s74, v13
    s_mul_i32 s69, s71, 1187840
    s_lshl_b32 s70, s70, 14
    v_mfma_f32_16x16x32_bf16 v[8:11], v[56:59], a[44:47], v[8:11]
    s_add_u32 s69, s69, s70
    s_lshl_b32 s70, s62, 12
    s_add_u32 s69, s69, s70
    s_lshl_b32 s70, s61, 7
    s_add_u32 s69, s69, s70
    v_mfma_f32_16x16x32_bf16 v[24:27], v[40:43], a[44:47], v[24:27]
    s_add_u32 s69, s69, 2621440
    s_lshl_b32 s70, s56, 2
    s_add_u32 s70, s70, 52288
    v_mov_b32 v28, s70
    v_xor_b32 v29, 4, v28
    v_mfma_f32_16x16x32_bf16 v[60:63], v[40:43], a[20:23], v[60:63]
    v_cvt_pk_bf16_f32 v84, v4, v5
    v_cvt_pk_bf16_f32 v85, v6, v7
    v_mfma_f32_16x16x32_bf16 v[76:79], v[48:51], a[20:23], v[76:79]
    v_bfi_b32 v84, v126, v16, v84
    v_bfi_b32 v85, v126, v17, v85
    ds_write_b64 v12, v[84:85] offset:0
    v_mfma_f32_16x16x32_bf16 v[60:63], v[56:59], a[52:55], v[60:63]
    v_cvt_pk_bf16_f32 v86, v20, v21
    v_cvt_pk_bf16_f32 v87, v22, v23
    v_bfi_b32 v86, v126, v18, v86
    v_mfma_f32_16x16x32_bf16 v[76:79], v[40:43], a[52:55], v[76:79]
    v_bfi_b32 v87, v126, v19, v87
    ds_write_b64 v12, v[86:87] offset:32
    v_cvt_pk_bf16_f32 v88, v8, v9
    v_mfma_f32_16x16x32_bf16 v[64:67], v[40:43], a[28:31], v[64:67]
    v_cvt_pk_bf16_f32 v89, v10, v11
    v_bfi_b32 v88, v126, v16, v88
    v_mfma_f32_16x16x32_bf16 v[80:83], v[48:51], a[28:31], v[80:83]
    v_bfi_b32 v89, v126, v17, v89
    ds_write_b64 v12, v[88:89] offset:2304
    v_cvt_pk_bf16_f32 v90, v24, v25
    v_mfma_f32_16x16x32_bf16 v[64:67], v[56:59], a[60:63], v[64:67]
    v_cvt_pk_bf16_f32 v91, v26, v27
    v_bfi_b32 v90, v126, v18, v90
    v_bfi_b32 v91, v126, v19, v91
    v_mfma_f32_16x16x32_bf16 v[80:83], v[40:43], a[60:63], v[80:83]
    ds_write_b64 v12, v[90:91] offset:2336
    v_cvt_pk_bf16_f32 v84, v60, v61
    v_cvt_pk_bf16_f32 v85, v62, v63
    v_bfi_b32 v84, v126, v16, v84
    v_bfi_b32 v85, v126, v17, v85
    ds_write_b64 v12, v[84:85] offset:4608
    v_cvt_pk_bf16_f32 v86, v76, v77
    v_cvt_pk_bf16_f32 v87, v78, v79
    v_bfi_b32 v86, v126, v18, v86
    v_bfi_b32 v87, v126, v19, v87
    ds_write_b64 v12, v[86:87] offset:4640
    v_cvt_pk_bf16_f32 v88, v64, v65
    v_cvt_pk_bf16_f32 v89, v66, v67
    v_bfi_b32 v88, v126, v16, v88
    v_bfi_b32 v89, v126, v17, v89
    ds_write_b64 v12, v[88:89] offset:6912
    v_cvt_pk_bf16_f32 v90, v80, v81
    v_cvt_pk_bf16_f32 v91, v82, v83
    v_bfi_b32 v90, v126, v18, v90
    v_bfi_b32 v91, v126, v19, v91
    ds_write_b64 v12, v[90:91] offset:6944
    ds_write_b32 v28, v126
Lpair_58:
    ds_read_b32 v30, v29
    s_waitcnt lgkmcnt(0)
    v_cmp_eq_u32 vcc, 0, v30
    s_nop 3
    s_cbranch_vccnz Lpair_58
    ds_read_b128 v[68:71], v13 offset:0
    ds_read_b128 v[72:75], v13 offset:1152
    ds_read_b128 v[76:79], v13 offset:2304
    ds_read_b128 v[80:83], v13 offset:3456
    s_waitcnt lgkmcnt(3)
    buffer_store_dwordx4 v[68:71], v14, s[52:55], s69 offen sc0 sc1
    s_add_u32 s69, s69, 296960
    s_waitcnt lgkmcnt(2)
    buffer_store_dwordx4 v[72:75], v14, s[52:55], s69 offen sc0 sc1
    s_add_u32 s69, s69, 296960
    s_waitcnt lgkmcnt(1)
    buffer_store_dwordx4 v[76:79], v14, s[52:55], s69 offen sc0 sc1
    s_add_u32 s69, s69, 296960
    s_waitcnt lgkmcnt(0)
    buffer_store_dwordx4 v[80:83], v14, s[52:55], s69 offen sc0 sc1
    s_nop 0
    s_branch Lp2e_50
Lhi_47:
    s_cmp_eq_u32 s56, s76
    s_cbranch_scc0 Lnp2_49
    v_lshlrev_b32 v4, 8, v1
    s_lshl_b32 s71, s61, 3
    s_add_u32 s71, s71, 5242880
    v_bfe_u32 v10, v1, 1, 1
    v_and_b32 v11, 1, v1
    v_xor_b32 v12, v10, v11
    v_lshlrev_b32 v84, 31, v10
    v_lshlrev_b32 v85, 31, v12
    v_lshl_or_b32 v86, v11, 15, v85
    v_lshl_or_b32 v87, v11, 15, v84
    v_lshlrev_b32 v5, 6, v1
    v_bfe_u32 v6, v1, 2, 1
    v_lshl_add_u32 v5, v6, 5, v5
    v_add_u32 v88, s72, v5
    v_xor_b32 v89, 32, v88
    v_and_b32 v5, 3, v1
    v_lshl_add_u32 v5, v5, 2, v3
    v_lshlrev_b32 v90, 4, v5
    v_lshlrev_b32 v5, 8, v5
    v_and_b32 v6, 1, v3
    v_lshl_add_u32 v5, v6, 5, v5
    v_add_u32 v91, s72, v5
    v_xor_b32 v92, 32, v91
    v_lshlrev_b32 v7, 2, v1
    s_lshl_b32 s70, s61, 9
    s_add_u32 s70, s70, 5308416
    v_and_b32 v5, 3, v1
    v_lshlrev_b32 v5, 7, v5
    buffer_load_dword v113, v5, s[52:55], s70 offen sc0 sc1
    s_mov_b32 s82, 0x05040100
    s_mov_b32 s83, 0x07060302
    s_mov_b32 s86, 0x000f000f
    s_mov_b32 s87, 0x000f000f
    ds_read_b128 v[60:63], v112 offset:40960
    ds_read_b128 v[64:67], v112 offset:41984
    ds_read_b128 v[68:71], v112 offset:43008
    ds_read_b128 v[72:75], v112 offset:44032
    s_waitcnt vmcnt(0)
    v_lshlrev_b32 v115, 16, v115
    v_lshlrev_b32 v116, 16, v116
    ds_write_b32 v7, v115 offset:51712
    ds_write_b32 v7, v116 offset:51968
    ds_read_b128 v[76:79], v90 offset:51712
    ds_read_b128 v[80:83], v90 offset:51968
    v_cmp_eq_u32 s[90:91], 1, v11
    s_barrier
    s_lshl_b32 s75, s89, 2
    s_add_u32 s75, s75, s63
    s_lshl_b32 s74, s75, 10
    s_mul_i32 s75, s75, 37120
    s_add_u32 s75, s75, 8912896
    s_add_u32 s74, s75, 0
    buffer_load_dwordx4 a[0:3], v127, s[52:55], s74 offen offset:0
    buffer_load_dwordx4 a[4:7], v127, s[52:55], s74 offen offset:1024
    buffer_load_dwordx4 a[8:11], v127, s[52:55], s74 offen offset:2048
    buffer_load_dwordx4 a[12:15], v127, s[52:55], s74 offen offset:3072
    s_add_u32 s74, s75, 4096
    buffer_load_dwordx4 a[16:19], v127, s[52:55], s74 offen offset:0
    buffer_load_dwordx4 a[20:23], v127, s[52:55], s74 offen offset:1024
    buffer_load_dwordx4 a[24:27], v127, s[52:55], s74 offen offset:2048
    buffer_load_dwordx4 a[28:31], v127, s[52:55], s74 offen offset:3072
Les_59:
    buffer_load_dwordx2 v[8:9], v4, s[52:55], s71 offen sc0 sc1
    s_waitcnt vmcnt(0)
    v_cmp_ne_u32 vcc, s66, v9
    s_nop 3
    s_cbranch_vccz Leok_60
    s_sleep 4
    s_cmp_eq_u32 s68, 0
    s_cbranch_scc1 Leok_60
    s_sub_u32 s68, s68, 1
    s_branch Les_59
Leok_60:
    v_alignbit_b32 v9, v8, v8, 16
    v_cndmask_b32 v9, v8, v9, s[90:91]
    v_perm_b32 v10, v9, v8, s82
    v_perm_b32 v12, v9, v8, s83
    v_xor_b32 v11, v86, v10
    v_xor_b32 v13, v87, v12
    v_xor_b32 v10, v84, v10
    v_xor_b32 v12, v85, v12
    ds_write_b64 v88, v[10:11]
    ds_write_b64 v89, v[12:13]
    ds_read_b64_tr_b16 v[36:37], v97 offset:0
    ds_read_b64_tr_b16 v[38:39], v97 offset:1024
    ds_read_b64_tr_b16 v[44:45], v98 offset:0
    ds_read_b64_tr_b16 v[46:47], v98 offset:1024
    ds_read_b64_tr_b16 v[40:41], v97 offset:2048
    ds_read_b64_tr_b16 v[42:43], v97 offset:3072
    ds_read_b64_tr_b16 v[48:49], v98 offset:2048
    ds_read_b64_tr_b16 v[50:51], v98 offset:3072
    s_waitcnt lgkmcnt(0)
    v_xor_b32 v52, 0x80008000, v36
    v_xor_b32 v53, 0x80008000, v37
    v_xor_b32 v54, 0x80008000, v38
    v_xor_b32 v55, 0x80008000, v39
    v_xor_b32 v56, 0x80008000, v40
    v_xor_b32 v57, 0x80008000, v41
    v_xor_b32 v58, 0x80008000, v42
    v_xor_b32 v59, 0x80008000, v43
    v_mfma_f32_16x16x32_bf16 v[4:7], v[60:63], v[36:39], 0
    v_mfma_f32_16x16x32_bf16 v[20:23], v[60:63], v[44:47], 0
    v_mfma_f32_16x16x32_bf16 v[4:7], v[64:67], v[40:43], v[4:7]
    v_mfma_f32_16x16x32_bf16 v[20:23], v[64:67], v[48:51], v[20:23]
    v_mfma_f32_16x16x32_bf16 v[4:7], v[68:71], v[44:47], v[4:7]
    v_mfma_f32_16x16x32_bf16 v[20:23], v[68:71], v[52:55], v[20:23]
    v_mfma_f32_16x16x32_bf16 v[4:7], v[72:75], v[48:51], v[4:7]
    v_mfma_f32_16x16x32_bf16 v[20:23], v[72:75], v[56:59], v[20:23]
    s_nop 7
    v_pk_mul_f32 v[24:25], v[20:21], v[80:81]
    v_pk_mul_f32 v[26:27], v[20:21], v[76:77]
    v_pk_fma_f32 v[20:21], v[4:5], v[80:81], v[26:27]
    v_pk_fma_f32 v[4:5], v[4:5], v[76:77], v[24:25] neg_lo:[0,0,1] neg_hi:[0,0,1]
    v_pk_mul_f32 v[24:25], v[22:23], v[82:83]
    v_pk_mul_f32 v[26:27], v[22:23], v[78:79]
    v_pk_fma_f32 v[22:23], v[6:7], v[82:83], v[26:27]
    v_pk_fma_f32 v[6:7], v[6:7], v[78:79], v[24:25] neg_lo:[0,0,1] neg_hi:[0,0,1]
    s_mov_b64 exec, s[86:87]
    v_cvt_pk_bf16_f32 v28, v4, v4
    v_cvt_pk_bf16_f32 v29, v4, v4
    ds_write_b64 v91, v[28:29] offset:0
    v_cvt_pk_bf16_f32 v30, v20, v20
    v_cvt_pk_bf16_f32 v31, v20, v20
    ds_write_b64 v92, v[30:31] offset:0
    v_cvt_pk_bf16_f32 v32, v5, -v21
    v_cvt_pk_bf16_f32 v33, -v5, v21
    ds_write_b64 v91, v[32:33] offset:64
    v_cvt_pk_bf16_f32 v34, v21, v5
    v_cvt_pk_bf16_f32 v35, -v21, -v5
    ds_write_b64 v92, v[34:35] offset:64
    v_cvt_pk_bf16_f32 v28, v6, -v6
    v_cvt_pk_bf16_f32 v29, v6, -v6
    ds_write_b64 v91, v[28:29] offset:128
    v_cvt_pk_bf16_f32 v30, v22, -v22
    v_cvt_pk_bf16_f32 v31, v22, -v22
    ds_write_b64 v92, v[30:31] offset:128
    v_cvt_pk_bf16_f32 v32, v7, v23
    v_cvt_pk_bf16_f32 v33, -v7, -v23
    ds_write_b64 v91, v[32:33] offset:192
    v_cvt_pk_bf16_f32 v34, v23, -v7
    v_cvt_pk_bf16_f32 v35, -v23, v7
    ds_write_b64 v92, v[34:35] offset:192
    s_mov_b64 exec, -1
    ds_read_b64_tr_b16 v[36:37], v97 offset:0
    ds_read_b64_tr_b16 v[38:39], v97 offset:1024
    ds_read_b64_tr_b16 v[44:45], v98 offset:0
    ds_read_b64_tr_b16 v[46:47], v98 offset:1024
    ds_read_b64_tr_b16 v[40:41], v97 offset:2048
    ds_read_b64_tr_b16 v[42:43], v97 offset:3072
    ds_read_b64_tr_b16 v[48:49], v98 offset:2048
    ds_read_b64_tr_b16 v[50:51], v98 offset:3072
    v_lshlrev_b32 v12, 8, v1
    s_lshl_b32 s69, s61, 3
    s_add_u32 s69, s69, 5308416
    s_waitcnt lgkmcnt(0)
    v_xor_b32 v52, 0x80008000, v44
    v_xor_b32 v53, 0x80008000, v45
    v_xor_b32 v54, 0x80008000, v46
    v_xor_b32 v55, 0x80008000, v47
    v_xor_b32 v56, 0x80008000, v48
    v_xor_b32 v57, 0x80008000, v49
    v_xor_b32 v58, 0x80008000, v50
    v_xor_b32 v59, 0x80008000, v51
    v_mfma_f32_16x16x32_bf16 v[4:7], v[36:39], v[60:63], 0
    v_mfma_f32_16x16x32_bf16 v[20:23], v[44:47], v[60:63], 0
    v_mfma_f32_16x16x32_bf16 v[4:7], v[40:43], v[64:67], v[4:7]
    v_mfma_f32_16x16x32_bf16 v[20:23], v[48:51], v[64:67], v[20:23]
    v_mfma_f32_16x16x32_bf16 v[4:7], v[52:55], v[68:71], v[4:7]
    v_mfma_f32_16x16x32_bf16 v[20:23], v[36:39], v[68:71], v[20:23]
    v_mfma_f32_16x16x32_bf16 v[4:7], v[56:59], v[72:75], v[4:7]
    v_mfma_f32_16x16x32_bf16 v[20:23], v[40:43], v[72:75], v[20:23]
    s_nop 7
    v_cvt_pk_bf16_f32 v28, v4, v20
    v_mov_b32 v29, s66
    v_cvt_pk_bf16_f32 v30, v5, v21
    v_mov_b32 v31, s66
    v_cvt_pk_bf16_f32 v32, v6, v22
    v_mov_b32 v33, s66
    v_cvt_pk_bf16_f32 v34, v7, v23
    v_mov_b32 v35, s66
    s_mov_b64 exec, 0xffff
    buffer_store_dwordx2 v[28:29], v12, s[52:55], s69 offen sc0 sc1
    s_add_u32 s69, s69, 4096
    buffer_store_dwordx2 v[30:31], v12, s[52:55], s69 offen sc0 sc1
    s_add_u32 s69, s69, 4096
    buffer_store_dwordx2 v[32:33], v12, s[52:55], s69 offen sc0 sc1
    s_add_u32 s69, s69, 4096
    buffer_store_dwordx2 v[34:35], v12, s[52:55], s69 offen sc0 sc1
    s_mov_b64 exec, -1
    s_branch Lnp2_49y
Lnp2_49:
    s_waitcnt vmcnt(0)
    s_barrier
Lnp2_49x:
    s_lshl_b32 s75, s89, 2
    s_add_u32 s75, s75, s63
    s_lshl_b32 s74, s75, 10
    s_mul_i32 s75, s75, 37120
    s_add_u32 s75, s75, 8912896
    s_add_u32 s74, s75, 0
    buffer_load_dwordx4 a[0:3], v127, s[52:55], s74 offen offset:0
    buffer_load_dwordx4 a[4:7], v127, s[52:55], s74 offen offset:1024
    buffer_load_dwordx4 a[8:11], v127, s[52:55], s74 offen offset:2048
    buffer_load_dwordx4 a[12:15], v127, s[52:55], s74 offen offset:3072
    s_add_u32 s74, s75, 4096
    buffer_load_dwordx4 a[16:19], v127, s[52:55], s74 offen offset:0
    buffer_load_dwordx4 a[20:23], v127, s[52:55], s74 offen offset:1024
    buffer_load_dwordx4 a[24:27], v127, s[52:55], s74 offen offset:2048
    buffer_load_dwordx4 a[28:31], v127, s[52:55], s74 offen offset:3072
Lnp2_49y:
    s_add_u32 s74, s75, 8192
    buffer_load_dwordx4 a[32:35], v127, s[52:55], s74 offen offset:0
    buffer_load_dwordx4 a[36:39], v127, s[52:55], s74 offen offset:1024
    buffer_load_dwordx4 a[40:43], v127, s[52:55], s74 offen offset:2048
    buffer_load_dwordx4 a[44:47], v127, s[52:55], s74 offen offset:3072
    s_add_u32 s74, s75, 12288
    buffer_load_dwordx4 a[48:51], v127, s[52:55], s74 offen offset:0
    buffer_load_dwordx4 a[52:55], v127, s[52:55], s74 offen offset:1024
    buffer_load_dwordx4 a[56:59], v127, s[52:55], s74 offen offset:2048
    buffer_load_dwordx4 a[60:63], v127, s[52:55], s74 offen offset:3072
    s_add_u32 s74, s75, 16384
    buffer_load_dwordx4 a[64:67], v127, s[52:55], s74 offen offset:0
    buffer_load_dwordx4 a[68:71], v127, s[52:55], s74 offen offset:1024
    buffer_load_dwordx4 a[72:75], v127, s[52:55], s74 offen offset:2048
    buffer_load_dwordx4 a[76:79], v127, s[52:55], s74 offen offset:3072
    s_add_u32 s74, s75, 20480
    buffer_load_dwordx4 a[80:83], v127, s[52:55], s74 offen offset:0
    buffer_load_dwordx4 a[84:87], v127, s[52:55], s74 offen offset:1024
    buffer_load_dwordx4 a[88:91], v127, s[52:55], s74 offen offset:2048
    buffer_load_dwordx4 a[92:95], v127, s[52:55], s74 offen offset:3072
    s_add_u32 s74, s75, 24576
    buffer_load_dwordx4 a[96:99], v127, s[52:55], s74 offen offset:0
    buffer_load_dwordx4 a[100:103], v127, s[52:55], s74 offen offset:1024
    buffer_load_dwordx4 a[104:107], v127, s[52:55], s74 offen offset:2048
    buffer_load_dwordx4 a[108:111], v127, s[52:55], s74 offen offset:3072
    s_add_u32 s74, s75, 28672
    buffer_load_dwordx4 a[112:115], v127, s[52:55], s74 offen offset:0
    buffer_load_dwordx4 a[116:119], v127, s[52:55], s74 offen offset:1024
    buffer_load_dwordx4 a[120:123], v127, s[52:55], s74 offen offset:2048
    buffer_load_dwordx4 a[124:127], v127, s[52:55], s74 offen offset:3072
Lp2e_50:
    s_setprio 0
    s_lshl_b32 s72, s56, 12
    v_bfe_u32 v4, v1, 2, 2
    v_lshl_add_u32 v5, v3, 2, v4
    v_lshlrev_b32 v6, 7, v5
    v_bfe_u32 v5, v5, 1, 2
    v_lshl_add_u32 v6, v5, 5, v6
    v_and_b32 v7, 3, v1
    v_lshl_add_u32 v6, v7, 3, v6
    v_add_u32 v101, s72, v6
    v_xor_b32 v102, 32, v101
    v_xor_b32 v103, 64, v101
    v_xor_b32 v104, 96, v101
    v_lshrrev_b32 v4, 3, v1
    v_lshlrev_b32 v4, 7, v4
    v_bfe_u32 v5, v1, 1, 2
    v_xor_b32 v5, v5, v3
    v_lshl_add_u32 v4, v5, 5, v4
    v_and_b32 v5, 1, v1
    v_lshl_add_u32 v100, v5, 4, v4
    s_mul_i32 s73, s57, 37120
    s_and_b32 s71, s56, 1
    s_lshl_b32 s70, s71, 14
    s_add_u32 s73, s73, s70
    s_lshr_b32 s74, s56, 1
    s_lshl_b32 s70, s74, 12
    s_add_u32 s73, s73, s70
    s_add_u32 s73, s73, 2621440
    s_lshl_b32 s70, s71, 3
    v_add_u32 v4, s70, v3
    v_sub_u32 v5, 32, v4
    v_cmp_eq_u32 vcc, 0, v4
    v_and_b32 v6, 7, v1
    v_mul_u32_u24 v6, 1040, v6
    v_bfe_u32 v7, v1, 3, 1
    v_lshl_add_u32 v6, v7, 9, v6
    s_lshl_b32 s70, s74, 2
    s_add_u32 s70, s70, 32768
    v_add_u32 v6, s70, v6
    v_lshl_add_u32 v105, v4, 4, v6
    v_lshl_add_u32 v107, v5, 4, v6
    v_cndmask_b32 v5, v5, 16, vcc
    v_lshl_add_u32 v106, v5, 4, v6
    v_subrev_u32 v107, 64, v107
    v_and_b32 v14, 31, v1
    v_lshlrev_b32 v15, 3, v14
    s_lshl_b32 s77, s57, 8
    s_add_u32 s77, s77, 5308416
    ds_read_b128 v[84:87], v112 offset:0
    ds_read_b128 v[88:91], v112 offset:1024
    ds_read_b128 v[92:95], v112 offset:2048
    ds_read_b128 v[96:99], v112 offset:3072
    s_mov_b32 s68, 1000000
    s_barrier
    s_sleep 20
    s_cmp_lg_u32 s56, 7
    s_cbranch_scc1 Lnxe_61
    buffer_load_dwordx2 v[16:17], v15, s[52:55], s77 offen sc0 sc1
Lnxe_61:
    s_mov_b32 m0, s72
    s_mov_b32 s69, s73
    buffer_load_dwordx4 v100, s[52:55], s69 offen sc0 sc1 lds
    buffer_load_dwordx4 v100, s[52:55], s69 offen offset:1024 sc0 sc1 lds
    buffer_load_dwordx4 v100, s[52:55], s69 offen offset:2048 sc0 sc1 lds
    buffer_load_dwordx4 v100, s[52:55], s69 offen offset:3072 sc0 sc1 lds
    s_waitcnt vmcnt(0)
Lpc_62:
    ds_read_b64_tr_b16 v[44:45], v101 offset:0
    ds_read_b64_tr_b16 v[46:47], v101 offset:2048
    ds_read_b64_tr_b16 v[48:49], v102 offset:0
    ds_read_b64_tr_b16 v[50:51], v102 offset:2048
    ds_read_b64_tr_b16 v[52:53], v103 offset:0
    ds_read_b64_tr_b16 v[54:55], v103 offset:2048
    ds_read_b64_tr_b16 v[56:57], v104 offset:0
    ds_read_b64_tr_b16 v[58:59], v104 offset:2048
    s_waitcnt lgkmcnt(6)
    v_xor_b32 v12, v44, v120
    v_bitop3_b32 v12, v12, v45, v120 bitop3:0xf6
    v_bitop3_b32 v12, v12, v46, v120 bitop3:0xf6
    v_bitop3_b32 v12, v12, v47, v120 bitop3:0xf6
    s_waitcnt lgkmcnt(4)
    v_bitop3_b32 v12, v12, v48, v121 bitop3:0xf6
    v_bitop3_b32 v12, v12, v49, v121 bitop3:0xf6
    v_bitop3_b32 v12, v12, v50, v121 bitop3:0xf6
    v_bitop3_b32 v12, v12, v51, v121 bitop3:0xf6
    s_waitcnt lgkmcnt(2)
    v_bitop3_b32 v12, v12, v52, v120 bitop3:0xf6
    v_bitop3_b32 v12, v12, v53, v120 bitop3:0xf6
    v_bitop3_b32 v12, v12, v54, v120 bitop3:0xf6
    v_bitop3_b32 v12, v12, v55, v120 bitop3:0xf6
    s_waitcnt lgkmcnt(0)
    v_bitop3_b32 v12, v12, v56, v121 bitop3:0xf6
    v_bitop3_b32 v12, v12, v57, v121 bitop3:0xf6
    v_bitop3_b32 v12, v12, v58, v121 bitop3:0xf6
    v_bitop3_b32 v12, v12, v59, v121 bitop3:0xf6
    v_and_b32 v12, v126, v12
    v_cmp_ne_u32 vcc, 0, v12
    s_nop 3
    s_cbranch_vccnz Lrt_63
Lrk_64:
    v_bfi_b32 v44, v126, s3, v44
    v_bfi_b32 v45, v126, s3, v45
    v_bfi_b32 v46, v126, s3, v46
    v_bfi_b32 v47, v126, s3, v47
    s_nop 1
    v_mfma_f32_16x16x32_bf16 v[28:31], v[44:47], v[84:87], 0
    v_mfma_f32_16x16x32_bf16 v[32:35], v[44:47], v[92:95], 0
    v_bfi_b32 v52, v126, s3, v52
    v_bfi_b32 v53, v126, s3, v53
    v_bfi_b32 v54, v126, s3, v54
    v_bfi_b32 v55, v126, s3, v55
    s_nop 1
    v_mfma_f32_16x16x32_bf16 v[36:39], v[52:55], v[84:87], 0
    v_mfma_f32_16x16x32_bf16 v[40:43], v[52:55], v[92:95], 0
    v_bfi_b32 v48, v126, s3, v48
    v_bfi_b32 v49, v126, s3, v49
    v_bfi_b32 v50, v126, s3, v50
    v_bfi_b32 v51, v126, s3, v51
    s_nop 1
    v_mfma_f32_16x16x32_bf16 v[28:31], v[48:51], v[88:91], v[28:31]
    v_mfma_f32_16x16x32_bf16 v[32:35], v[48:51], v[96:99], v[32:35]
    v_bfi_b32 v56, v126, s3, v56
    v_bfi_b32 v57, v126, s3, v57
    v_bfi_b32 v58, v126, s3, v58
    v_bfi_b32 v59, v126, s3, v59
    s_nop 1
    v_mfma_f32_16x16x32_bf16 v[36:39], v[56:59], v[88:91], v[36:39]
    v_mfma_f32_16x16x32_bf16 v[40:43], v[56:59], v[96:99], v[40:43]
    s_cmp_lg_u32 s56, 7
    s_nop 5
    s_cbranch_scc1 Lnox3_65
    v_lshlrev_b32 v19, 6, v14
    v_bfe_u32 v18, v14, 2, 1
    v_lshl_add_u32 v19, v18, 5, v19
    v_xor_b32 v18, 32, v19
Lzc_66:
    v_xor_b32 v12, s66, v17
    v_cmp_ne_u32 vcc, 0, v12
    s_nop 3
    s_cbranch_vccnz Lrt_67
Lrk_68:
    ds_write_b16 v19, v16 offset:49664
    ds_write_b16_d16_hi v18, v16 offset:49664
    ds_read_b64_tr_b16 v[20:21], v118 offset:49664
    ds_read_b64_tr_b16 v[22:23], v118 offset:50688
    ds_read_b64_tr_b16 v[24:25], v119 offset:49664
    ds_read_b64_tr_b16 v[26:27], v119 offset:50688
    v_lshlrev_b32 v19, 2, v1
    s_waitcnt lgkmcnt(0)
    v_mfma_f32_16x16x32_bf16 v[76:79], v[20:23], v[84:87], 0
    v_mfma_f32_16x16x32_bf16 v[76:79], v[24:27], v[88:91], v[76:79]
    v_mfma_f32_16x16x32_bf16 v[80:83], v[20:23], v[92:95], 0
    v_mfma_f32_16x16x32_bf16 v[80:83], v[24:27], v[96:99], v[80:83]
    s_mov_b64 exec, 0xff
    s_nop 4
    ds_write_b32 v19, v76 offset:52224
    s_nop 0
    ds_write_b32 v19, v80 offset:52256
    s_mov_b64 exec, -1
Lnox3_65:
    ds_read_b128 v[12:15], v112 offset:4096
    ds_read_b128 v[16:19], v112 offset:5120
    ds_read_b128 v[20:23], v112 offset:6144
    ds_read_b128 v[24:27], v112 offset:7168
    v_cvt_pk_bf16_f32 v4, v28, v29
    ds_write_b32 v105, v4 offset:0
    v_cvt_pk_bf16_f32 v5, v36, v37
    ds_write_b32 v105, v5 offset:64
    v_cvt_pk_bf16_f32 v6, v30, v31
    ds_write_b32 v106, v6 offset:0
    v_cvt_pk_bf16_f32 v7, v38, v39
    ds_write_b32 v107, v7 offset:0
    v_cvt_pk_bf16_f32 v8, v32, v33
    ds_write_b32 v105, v8 offset:8320
    v_cvt_pk_bf16_f32 v9, v40, v41
    ds_write_b32 v105, v9 offset:8384
    v_cvt_pk_bf16_f32 v10, v34, v35
    ds_write_b32 v106, v10 offset:8320
    v_cvt_pk_bf16_f32 v11, v42, v43
    ds_write_b32 v107, v11 offset:8320
    ds_read_b128 v[76:79], v112 offset:12288
    ds_read_b128 v[80:83], v112 offset:13312
    ds_read_b128 v[84:87], v112 offset:14336
    ds_read_b128 v[88:91], v112 offset:15360
    ds_read_b128 v[92:95], v112 offset:16384
    ds_read_b128 v[96:99], v112 offset:17408
    ds_read_b128 v[100:103], v112 offset:18432
    ds_read_b128 v[104:107], v112 offset:19456
    s_mul_i32 s70, s56, 2080
    s_add_u32 s70, s70, 32768
    v_add_u32 v2, s70, v127
    v_lshrrev_b32 v3, 5, v1
    s_lshl_b32 s70, s56, 3
    s_add_u32 s70, s70, 52224
    v_lshl_add_u32 v110, v3, 2, s70
    s_waitcnt lgkmcnt(8)
    s_barrier
    ds_read_b128 v[4:7], v2
    ds_read_b128 v[8:11], v2 offset:1040
    ds_read_b32 v108, v110
    s_lshl_b32 s79, s63, 12
    s_mul_i32 s73, s64, 37120
    s_add_u32 s73, s73, s79
    s_add_u32 s73, s73, 6291456
    s_lshl_b32 s70, s58, 3
    s_add_u32 s70, s70, s56
    s_lshl_b32 s70, s70, 7
    s_add_u32 s70, s70, s57
    s_lshl_b32 s72, s70, 11
    v_and_b32 v2, 31, v1
    s_lshl_b32 s70, s56, 12
    v_mul_u32_u24 v3, 1040, v3
    v_lshl_add_u32 v2, v2, 5, v3
    v_add_u32 v2, s70, v2
    v_add_u32 v3, s70, v127
    s_waitcnt lgkmcnt(2)
    v_mfma_f32_32x32x16_bf16 v[44:59], v[4:7], v[12:15], 0
    v_mfma_f32_32x32x16_bf16 v[60:75], v[4:7], v[20:23], 0
    s_waitcnt lgkmcnt(0)
    v_mfma_f32_32x32x16_bf16 v[44:59], v[8:11], v[16:19], v[44:59]
    v_xor_b32 v109, 0x80000000, v108
    v_pk_mul_f32 v[28:29], v[108:109], 1.0 op_sel_hi:[1,0]
    v_pk_mul_f32 v[30:31], v[108:109], 1.0 op_sel_hi:[1,0]
    v_pk_mul_f32 v[32:33], v[108:109], 1.0 op_sel_hi:[1,0]
    v_pk_mul_f32 v[34:35], v[108:109], 1.0 op_sel_hi:[1,0]
    v_mfma_f32_32x32x16_bf16 v[60:75], v[8:11], v[24:27], v[60:75]
    v_pk_mul_f32 v[36:37], v[108:109], 1.0 op_sel_hi:[1,0]
    v_pk_mul_f32 v[38:39], v[108:109], 1.0 op_sel_hi:[1,0]
    v_pk_mul_f32 v[40:41], v[108:109], 1.0 op_sel_hi:[1,0]
    v_pk_mul_f32 v[42:43], v[108:109], 1.0 op_sel_hi:[1,0]
    s_nop 7
    v_pk_mul_f32 v[108:109], v[60:61], v[92:93]
    v_pk_mul_f32 v[110:111], v[60:61], v[76:77]
    v_pk_fma_f32 v[60:61], v[44:45], v[92:93], v[110:111]
    v_pk_fma_f32 v[44:45], v[44:45], v[76:77], v[108:109] neg_lo:[0,0,1] neg_hi:[0,0,1]
    v_cvt_pk_bf16_f32 v12, v60, v61
    v_cvt_pk_bf16_f32 v4, v44, v45
    v_pk_mul_f32 v[108:109], v[62:63], v[94:95]
    v_pk_mul_f32 v[110:111], v[62:63], v[78:79]
    v_pk_fma_f32 v[62:63], v[46:47], v[94:95], v[110:111]
    v_pk_fma_f32 v[46:47], v[46:47], v[78:79], v[108:109] neg_lo:[0,0,1] neg_hi:[0,0,1]
    v_cvt_pk_bf16_f32 v13, v62, v63
    v_cvt_pk_bf16_f32 v5, v46, v47
    v_pk_mul_f32 v[108:109], v[64:65], v[96:97]
    v_pk_mul_f32 v[110:111], v[64:65], v[80:81]
    v_pk_fma_f32 v[64:65], v[48:49], v[96:97], v[110:111]
    v_pk_fma_f32 v[48:49], v[48:49], v[80:81], v[108:109] neg_lo:[0,0,1] neg_hi:[0,0,1]
    v_cvt_pk_bf16_f32 v14, v64, v65
    v_cvt_pk_bf16_f32 v6, v48, v49
    v_pk_mul_f32 v[108:109], v[66:67], v[98:99]
    v_pk_mul_f32 v[110:111], v[66:67], v[82:83]
    v_pk_fma_f32 v[66:67], v[50:51], v[98:99], v[110:111]
    v_pk_fma_f32 v[50:51], v[50:51], v[82:83], v[108:109] neg_lo:[0,0,1] neg_hi:[0,0,1]
    v_cvt_pk_bf16_f32 v15, v66, v67
    v_cvt_pk_bf16_f32 v7, v50, v51
    ds_read_b128 v[76:79], v112 offset:8192
    ds_read_b128 v[80:83], v112 offset:9216
    ds_read_b128 v[92:95], v112 offset:10240
    ds_read_b128 v[96:99], v112 offset:11264
    v_pk_mul_f32 v[108:109], v[68:69], v[100:101]
    v_pk_mul_f32 v[110:111], v[68:69], v[84:85]
    v_pk_fma_f32 v[68:69], v[52:53], v[100:101], v[110:111]
    v_pk_fma_f32 v[52:53], v[52:53], v[84:85], v[108:109] neg_lo:[0,0,1] neg_hi:[0,0,1]
    v_cvt_pk_bf16_f32 v16, v68, v69
    v_cvt_pk_bf16_f32 v8, v52, v53
    v_pk_mul_f32 v[108:109], v[70:71], v[102:103]
    v_pk_mul_f32 v[110:111], v[70:71], v[86:87]
    v_pk_fma_f32 v[70:71], v[54:55], v[102:103], v[110:111]
    v_pk_fma_f32 v[54:55], v[54:55], v[86:87], v[108:109] neg_lo:[0,0,1] neg_hi:[0,0,1]
    v_cvt_pk_bf16_f32 v17, v70, v71
    v_cvt_pk_bf16_f32 v9, v54, v55
    s_waitcnt lgkmcnt(0)
    v_mfma_f32_32x32x16_bf16 v[28:43], v[4:7], v[76:79], v[28:43]
    v_pk_mul_f32 v[108:109], v[72:73], v[104:105]
    v_pk_mul_f32 v[110:111], v[72:73], v[88:89]
    v_pk_fma_f32 v[72:73], v[56:57], v[104:105], v[110:111]
    v_pk_fma_f32 v[56:57], v[56:57], v[88:89], v[108:109] neg_lo:[0,0,1] neg_hi:[0,0,1]
    v_cvt_pk_bf16_f32 v18, v72, v73
    v_cvt_pk_bf16_f32 v10, v56, v57
    v_mfma_f32_32x32x16_bf16 v[28:43], v[12:15], v[92:95], v[28:43]
    v_pk_mul_f32 v[108:109], v[74:75], v[106:107]
    v_pk_mul_f32 v[110:111], v[74:75], v[90:91]
    v_pk_fma_f32 v[74:75], v[58:59], v[106:107], v[110:111]
    v_pk_fma_f32 v[58:59], v[58:59], v[90:91], v[108:109] neg_lo:[0,0,1] neg_hi:[0,0,1]
    v_cvt_pk_bf16_f32 v19, v74, v75
    v_cvt_pk_bf16_f32 v11, v58, v59
    s_nop 1
    v_mfma_f32_32x32x16_bf16 v[28:43], v[8:11], v[80:83], v[28:43]
    v_mfma_f32_32x32x16_bf16 v[28:43], v[16:19], v[96:99], v[28:43]
    s_nop 11
    v_cvt_pk_bf16_f32 v20, v28, v29
    v_cvt_pk_bf16_f32 v21, v30, v31
    v_cvt_pk_bf16_f32 v22, v32, v33
    v_cvt_pk_bf16_f32 v23, v34, v35
    v_cvt_pk_bf16_f32 v24, v36, v37
    v_cvt_pk_bf16_f32 v25, v38, v39
    v_cvt_pk_bf16_f32 v26, v40, v41
    v_cvt_pk_bf16_f32 v27, v42, v43
    ds_write_b128 v2, v[20:23]
    ds_write_b128 v2, v[24:27] offset:16
    ds_read_b128 v[28:31], v3
    ds_read_b128 v[32:35], v3 offset:1040
    s_cmp_lt_u32 s56, 4
    s_cbranch_scc1 Lyl_69
    s_add_u32 s70, s72, 131072
    s_waitcnt lgkmcnt(1)
    buffer_store_dwordx4 v[28:31], v127, s[48:51], s72 offen sc0 sc1
    s_waitcnt lgkmcnt(0)
    buffer_store_dwordx4 v[32:35], v127, s[48:51], s70 offen sc0 sc1
Lyl_69:
    s_cmp_lt_u32 s56, 4
    s_cbranch_scc1 Lfa_70
    s_waitcnt vmcnt(2)
    s_branch L_fcomp
Lfa_70:
    s_sleep 6
    s_add_u32 m0, s79, 98304
    s_add_u32 s69, s73, 0
    buffer_load_dwordx4 v127, s[52:55], s69 offen sc0 sc1 lds
    buffer_load_dwordx4 v127, s[52:55], s69 offen offset:1024 sc0 sc1 lds
    buffer_load_dwordx4 v127, s[52:55], s69 offen offset:2048 sc0 sc1 lds
    buffer_load_dwordx4 v127, s[52:55], s69 offen offset:3072 sc0 sc1 lds
    s_add_u32 m0, s79, 114688
    s_add_u32 s69, s73, 16384
    buffer_load_dwordx4 v127, s[52:55], s69 offen sc0 sc1 lds
    buffer_load_dwordx4 v127, s[52:55], s69 offen offset:1024 sc0 sc1 lds
    buffer_load_dwordx4 v127, s[52:55], s69 offen offset:2048 sc0 sc1 lds
    buffer_load_dwordx4 v127, s[52:55], s69 offen offset:3072 sc0 sc1 lds
    s_waitcnt vmcnt(4)
L_fload:
    s_setprio 3
    s_add_u32 s70, s79, 98304
    v_add_u32 v100, s70, v127
    s_mov_b32 s68, 1000000
Loc_71:
    ds_read_b128 v[44:47], v100 offset:0
    ds_read_b128 v[48:51], v100 offset:1024
    ds_read_b128 v[52:55], v100 offset:2048
    ds_read_b128 v[56:59], v100 offset:3072
    s_waitcnt lgkmcnt(3)
    v_xor_b32 v20, v44, v122
    v_bitop3_b32 v20, v20, v45, v123 bitop3:0xf6
    v_bitop3_b32 v20, v20, v46, v124 bitop3:0xf6
    v_bitop3_b32 v20, v20, v47, v125 bitop3:0xf6
    s_waitcnt lgkmcnt(2)
    v_bitop3_b32 v20, v20, v48, v122 bitop3:0xf6
    v_bitop3_b32 v20, v20, v49, v123 bitop3:0xf6
    v_bitop3_b32 v20, v20, v50, v124 bitop3:0xf6
    v_bitop3_b32 v20, v20, v51, v125 bitop3:0xf6
    s_waitcnt lgkmcnt(1)
    v_bitop3_b32 v20, v20, v52, v122 bitop3:0xf6
    v_bitop3_b32 v20, v20, v53, v123 bitop3:0xf6
    v_bitop3_b32 v20, v20, v54, v124 bitop3:0xf6
    v_bitop3_b32 v20, v20, v55, v125 bitop3:0xf6
    s_waitcnt lgkmcnt(0)
    v_bitop3_b32 v20, v20, v56, v122 bitop3:0xf6
    v_bitop3_b32 v20, v20, v57, v123 bitop3:0xf6
    v_bitop3_b32 v20, v20, v58, v124 bitop3:0xf6
    v_bitop3_b32 v20, v20, v59, v125 bitop3:0xf6
    v_and_b32 v20, v126, v20
    v_cmp_ne_u32 vcc, 0, v20
    s_nop 3
    s_cbranch_vccnz Lrt_72
Lrk_73:
    s_barrier
    s_waitcnt vmcnt(0)
Loc_74:
    ds_read_b128 v[44:47], v100 offset:16384
    ds_read_b128 v[48:51], v100 offset:17408
    ds_read_b128 v[52:55], v100 offset:18432
    ds_read_b128 v[56:59], v100 offset:19456
    s_waitcnt lgkmcnt(3)
    v_xor_b32 v20, v44, v122
    v_bitop3_b32 v20, v20, v45, v123 bitop3:0xf6
    v_bitop3_b32 v20, v20, v46, v124 bitop3:0xf6
    v_bitop3_b32 v20, v20, v47, v125 bitop3:0xf6
    s_waitcnt lgkmcnt(2)
    v_bitop3_b32 v20, v20, v48, v122 bitop3:0xf6
    v_bitop3_b32 v20, v20, v49, v123 bitop3:0xf6
    v_bitop3_b32 v20, v20, v50, v124 bitop3:0xf6
    v_bitop3_b32 v20, v20, v51, v125 bitop3:0xf6
    s_waitcnt lgkmcnt(1)
    v_bitop3_b32 v20, v20, v52, v122 bitop3:0xf6
    v_bitop3_b32 v20, v20, v53, v123 bitop3:0xf6
    v_bitop3_b32 v20, v20, v54, v124 bitop3:0xf6
    v_bitop3_b32 v20, v20, v55, v125 bitop3:0xf6
    s_waitcnt lgkmcnt(0)
    v_bitop3_b32 v20, v20, v56, v122 bitop3:0xf6
    v_bitop3_b32 v20, v20, v57, v123 bitop3:0xf6
    v_bitop3_b32 v20, v20, v58, v124 bitop3:0xf6
    v_bitop3_b32 v20, v20, v59, v125 bitop3:0xf6
    v_and_b32 v20, v126, v20
    v_cmp_ne_u32 vcc, 0, v20
    s_nop 3
    s_cbranch_vccnz Lrt_75
Lrk_76:
    s_barrier
    s_bitcmp1_b32 s2, 3
    s_cbranch_scc0 Lnoe_77
    s_add_u32 s70, s72, 131072
    s_waitcnt lgkmcnt(1)
    buffer_store_dwordx4 v[28:31], v127, s[48:51], s72 offen sc0 sc1
    s_waitcnt lgkmcnt(0)
    buffer_store_dwordx4 v[32:35], v127, s[48:51], s70 offen sc0 sc1
    s_lshl_b32 s70, s2, 3
    s_add_u32 s70, s70, s56
    s_cmp_lg_u32 s70, 64
    s_cbranch_scc1 Lnoe_77
    v_mov_b32 v2, s67
    v_mov_b32 v3, 5373952
    s_mov_b64 exec, 1
    buffer_store_dword v2, v3, s[52:55], 0 offen
    s_mov_b64 exec, -1
Lnoe_77:
    s_endpgm
L_fcomp:
    v_add_u32 v101, 98304, v127
    s_mul_i32 s70, s63, 2560
    s_add_u32 s70, s70, 32768
    v_and_b32 v104, 31, v1
    v_mul_u32_u24 v104, 80, v104
    v_lshrrev_b32 v105, 5, v1
    v_lshl_add_u32 v104, v105, 5, v104
    v_add_u32 v104, s70, v104
    v_add_u32 v105, s70, v117
    v_lshrrev_b32 v106, 2, v1
    v_lshlrev_b32 v106, 11, v106
    v_and_b32 v107, 3, v1
    v_lshl_add_u32 v106, v107, 4, v106
    s_lshl_b32 s72, s64, 16
    s_lshl_b32 s70, s89, 8
    s_add_u32 s72, s72, s70
    s_lshl_b32 s70, s63, 6
    s_add_u32 s72, s72, s70
    s_add_u32 s72, s72, 1024
    s_add_u32 s65, s72, 32768
    s_barrier
    ds_read_b128 v[76:79], v101 offset:0
    ds_read_b128 v[80:83], v101 offset:1024
    ds_read_b128 v[84:87], v101 offset:2048
    ds_read_b128 v[88:91], v101 offset:3072
    s_waitcnt lgkmcnt(3)
    v_bfi_b32 v76, v126, s3, v76
    v_bfi_b32 v77, v126, s3, v77
    v_bfi_b32 v78, v126, s3, v78
    v_bfi_b32 v79, v126, s3, v79
    ds_read_b128 v[92:95], v101 offset:4096
    s_waitcnt lgkmcnt(3)
    v_mfma_f32_32x32x16_bf16 v[4:19], a[0:3], v[76:79], 0
    v_bfi_b32 v80, v126, s3, v80
    v_bfi_b32 v81, v126, s3, v81
    v_bfi_b32 v82, v126, s3, v82
    v_bfi_b32 v83, v126, s3, v83
    ds_read_b128 v[96:99], v101 offset:5120
    s_waitcnt lgkmcnt(3)
    v_mfma_f32_32x32x16_bf16 v[4:19], a[4:7], v[80:83], v[4:19]
    v_bfi_b32 v84, v126, s3, v84
    v_bfi_b32 v85, v126, s3, v85
    v_bfi_b32 v86, v126, s3, v86
    v_bfi_b32 v87, v126, s3, v87
    ds_read_b128 v[76:79], v101 offset:6144
    s_waitcnt lgkmcnt(3)
    v_mfma_f32_32x32x16_bf16 v[4:19], a[8:11], v[84:87], v[4:19]
    v_bfi_b32 v88, v126, s3, v88
    v_bfi_b32 v89, v126, s3, v89
    v_bfi_b32 v90, v126, s3, v90
    v_bfi_b32 v91, v126, s3, v91
    ds_read_b128 v[80:83], v101 offset:7168
    s_waitcnt lgkmcnt(3)
    v_mfma_f32_32x32x16_bf16 v[4:19], a[12:15], v[88:91], v[4:19]
    v_bfi_b32 v92, v126, s3, v92
    v_bfi_b32 v93, v126, s3, v93
    v_bfi_b32 v94, v126, s3, v94
    v_bfi_b32 v95, v126, s3, v95
    ds_read_b128 v[84:87], v101 offset:8192
    s_waitcnt lgkmcnt(3)
    v_mfma_f32_32x32x16_bf16 v[4:19], a[16:19], v[92:95], v[4:19]
    v_bfi_b32 v96, v126, s3, v96
    v_bfi_b32 v97, v126, s3, v97
    v_bfi_b32 v98, v126, s3, v98
    v_bfi_b32 v99, v126, s3, v99
    ds_read_b128 v[88:91], v101 offset:9216
    s_waitcnt lgkmcnt(3)
    v_mfma_f32_32x32x16_bf16 v[4:19], a[20:23], v[96:99], v[4:19]
    v_bfi_b32 v76, v126, s3, v76
    v_bfi_b32 v77, v126, s3, v77
    v_bfi_b32 v78, v126, s3, v78
    v_bfi_b32 v79, v126, s3, v79
    ds_read_b128 v[92:95], v101 offset:10240
    s_waitcnt lgkmcnt(3)
    v_mfma_f32_32x32x16_bf16 v[4:19], a[24:27], v[76:79], v[4:19]
    v_bfi_b32 v80, v126, s3, v80
    v_bfi_b32 v81, v126, s3, v81
    v_bfi_b32 v82, v126, s3, v82
    v_bfi_b32 v83, v126, s3, v83
    ds_read_b128 v[96:99], v101 offset:11264
    s_waitcnt lgkmcnt(3)
    v_mfma_f32_32x32x16_bf16 v[4:19], a[28:31], v[80:83], v[4:19]
    v_bfi_b32 v84, v126, s3, v84
    v_bfi_b32 v85, v126, s3, v85
    v_bfi_b32 v86, v126, s3, v86
    v_bfi_b32 v87, v126, s3, v87
    ds_read_b128 v[76:79], v101 offset:12288
    s_waitcnt lgkmcnt(3)
    v_mfma_f32_32x32x16_bf16 v[4:19], a[32:35], v[84:87], v[4:19]
    v_bfi_b32 v88, v126, s3, v88
    v_bfi_b32 v89, v126, s3, v89
    v_bfi_b32 v90, v126, s3, v90
    v_bfi_b32 v91, v126, s3, v91
    ds_read_b128 v[80:83], v101 offset:13312
    s_waitcnt lgkmcnt(3)
    v_mfma_f32_32x32x16_bf16 v[4:19], a[36:39], v[88:91], v[4:19]
    v_bfi_b32 v92, v126, s3, v92
    v_bfi_b32 v93, v126, s3, v93
    v_bfi_b32 v94, v126, s3, v94
    v_bfi_b32 v95, v126, s3, v95
    ds_read_b128 v[84:87], v101 offset:14336
    s_waitcnt lgkmcnt(3)
    v_mfma_f32_32x32x16_bf16 v[4:19], a[40:43], v[92:95], v[4:19]
    v_bfi_b32 v96, v126, s3, v96
    v_bfi_b32 v97, v126, s3, v97
    v_bfi_b32 v98, v126, s3, v98
    v_bfi_b32 v99, v126, s3, v99
    ds_read_b128 v[88:91], v101 offset:15360
    s_waitcnt lgkmcnt(3)
    v_mfma_f32_32x32x16_bf16 v[4:19], a[44:47], v[96:99], v[4:19]
    v_bfi_b32 v76, v126, s3, v76
    v_bfi_b32 v77, v126, s3, v77
    v_bfi_b32 v78, v126, s3, v78
    v_bfi_b32 v79, v126, s3, v79
    s_barrier
    ds_read_b128 v[92:95], v101 offset:16384
    s_waitcnt lgkmcnt(3)
    v_mfma_f32_32x32x16_bf16 v[4:19], a[48:51], v[76:79], v[4:19]
    v_bfi_b32 v80, v126, s3, v80
    v_bfi_b32 v81, v126, s3, v81
    v_bfi_b32 v82, v126, s3, v82
    v_bfi_b32 v83, v126, s3, v83
    ds_read_b128 v[96:99], v101 offset:17408
    s_waitcnt lgkmcnt(3)
    v_mfma_f32_32x32x16_bf16 v[4:19], a[52:55], v[80:83], v[4:19]
    v_bfi_b32 v84, v126, s3, v84
    v_bfi_b32 v85, v126, s3, v85
    v_bfi_b32 v86, v126, s3, v86
    v_bfi_b32 v87, v126, s3, v87
    ds_read_b128 v[76:79], v101 offset:18432
    s_waitcnt lgkmcnt(3)
    v_mfma_f32_32x32x16_bf16 v[4:19], a[56:59], v[84:87], v[4:19]
    v_bfi_b32 v88, v126, s3, v88
    v_bfi_b32 v89, v126, s3, v89
    v_bfi_b32 v90, v126, s3, v90
    v_bfi_b32 v91, v126, s3, v91
    ds_read_b128 v[80:83], v101 offset:19456
    s_waitcnt lgkmcnt(3)
    v_mfma_f32_32x32x16_bf16 v[4:19], a[60:63], v[88:91], v[4:19]
    v_bfi_b32 v92, v126, s3, v92
    v_bfi_b32 v93, v126, s3, v93
    v_bfi_b32 v94, v126, s3, v94
    v_bfi_b32 v95, v126, s3, v95
    ds_read_b128 v[84:87], v101 offset:20480
    s_waitcnt lgkmcnt(3)
    v_mfma_f32_32x32x16_bf16 v[4:19], a[64:67], v[92:95], v[4:19]
    v_bfi_b32 v96, v126, s3, v96
    v_bfi_b32 v97, v126, s3, v97
    v_bfi_b32 v98, v126, s3, v98
    v_bfi_b32 v99, v126, s3, v99
    ds_read_b128 v[88:91], v101 offset:21504
    s_waitcnt lgkmcnt(3)
    v_mfma_f32_32x32x16_bf16 v[4:19], a[68:71], v[96:99], v[4:19]
    v_bfi_b32 v76, v126, s3, v76
    v_bfi_b32 v77, v126, s3, v77
    v_bfi_b32 v78, v126, s3, v78
    v_bfi_b32 v79, v126, s3, v79
    ds_read_b128 v[92:95], v101 offset:22528
    s_waitcnt lgkmcnt(3)
    v_mfma_f32_32x32x16_bf16 v[4:19], a[72:75], v[76:79], v[4:19]
    v_bfi_b32 v80, v126, s3, v80
    v_bfi_b32 v81, v126, s3, v81
    v_bfi_b32 v82, v126, s3, v82
    v_bfi_b32 v83, v126, s3, v83
    ds_read_b128 v[96:99], v101 offset:23552
    s_waitcnt lgkmcnt(3)
    v_mfma_f32_32x32x16_bf16 v[4:19], a[76:79], v[80:83], v[4:19]
    v_bfi_b32 v84, v126, s3, v84
    v_bfi_b32 v85, v126, s3, v85
    v_bfi_b32 v86, v126, s3, v86
    v_bfi_b32 v87, v126, s3, v87
    ds_read_b128 v[76:79], v101 offset:24576
    s_waitcnt lgkmcnt(3)
    v_mfma_f32_32x32x16_bf16 v[4:19], a[80:83], v[84:87], v[4:19]
    v_bfi_b32 v88, v126, s3, v88
    v_bfi_b32 v89, v126, s3, v89
    v_bfi_b32 v90, v126, s3, v90
    v_bfi_b32 v91, v126, s3, v91
    ds_read_b128 v[80:83], v101 offset:25600
    s_waitcnt lgkmcnt(3)
    v_mfma_f32_32x32x16_bf16 v[4:19], a[84:87], v[88:91], v[4:19]
    v_bfi_b32 v92, v126, s3, v92
    v_bfi_b32 v93, v126, s3, v93
    v_bfi_b32 v94, v126, s3, v94
    v_bfi_b32 v95, v126, s3, v95
    ds_read_b128 v[84:87], v101 offset:26624
    s_waitcnt lgkmcnt(3)
    v_mfma_f32_32x32x16_bf16 v[4:19], a[88:91], v[92:95], v[4:19]
    v_bfi_b32 v96, v126, s3, v96
    v_bfi_b32 v97, v126, s3, v97
    v_bfi_b32 v98, v126, s3, v98
    v_bfi_b32 v99, v126, s3, v99
    ds_read_b128 v[88:91], v101 offset:27648
    s_waitcnt lgkmcnt(3)
    v_mfma_f32_32x32x16_bf16 v[4:19], a[92:95], v[96:99], v[4:19]
    v_bfi_b32 v76, v126, s3, v76
    v_bfi_b32 v77, v126, s3, v77
    v_bfi_b32 v78, v126, s3, v78
    v_bfi_b32 v79, v126, s3, v79
    ds_read_b128 v[92:95], v101 offset:28672
    s_waitcnt lgkmcnt(3)
    v_mfma_f32_32x32x16_bf16 v[4:19], a[96:99], v[76:79], v[4:19]
    v_bfi_b32 v80, v126, s3, v80
    v_bfi_b32 v81, v126, s3, v81
    v_bfi_b32 v82, v126, s3, v82
    v_bfi_b32 v83, v126, s3, v83
    ds_read_b128 v[96:99], v101 offset:29696
    s_waitcnt lgkmcnt(3)
    v_mfma_f32_32x32x16_bf16 v[4:19], a[100:103], v[80:83], v[4:19]
    v_bfi_b32 v84, v126, s3, v84
    v_bfi_b32 v85, v126, s3, v85
    v_bfi_b32 v86, v126, s3, v86
    v_bfi_b32 v87, v126, s3, v87
    ds_read_b128 v[76:79], v101 offset:30720
    s_waitcnt lgkmcnt(3)
    v_mfma_f32_32x32x16_bf16 v[4:19], a[104:107], v[84:87], v[4:19]
    v_bfi_b32 v88, v126, s3, v88
    v_bfi_b32 v89, v126, s3, v89
    v_bfi_b32 v90, v126, s3, v90
    v_bfi_b32 v91, v126, s3, v91
    ds_read_b128 v[80:83], v101 offset:31744
    s_waitcnt lgkmcnt(3)
    v_mfma_f32_32x32x16_bf16 v[4:19], a[108:111], v[88:91], v[4:19]
    v_bfi_b32 v92, v126, s3, v92
    v_bfi_b32 v93, v126, s3, v93
    v_bfi_b32 v94, v126, s3, v94
    v_bfi_b32 v95, v126, s3, v95
    s_waitcnt lgkmcnt(2)
    s_nop 0
    v_mfma_f32_32x32x16_bf16 v[4:19], a[112:115], v[92:95], v[4:19]
    v_bfi_b32 v96, v126, s3, v96
    v_bfi_b32 v97, v126, s3, v97
    v_bfi_b32 v98, v126, s3, v98
    v_bfi_b32 v99, v126, s3, v99
    s_waitcnt lgkmcnt(1)
    s_nop 0
    v_mfma_f32_32x32x16_bf16 v[4:19], a[116:119], v[96:99], v[4:19]
    v_bfi_b32 v76, v126, s3, v76
    v_bfi_b32 v77, v126, s3, v77
    v_bfi_b32 v78, v126, s3, v78
    v_bfi_b32 v79, v126, s3, v79
    s_waitcnt lgkmcnt(0)
    s_nop 0
    v_mfma_f32_32x32x16_bf16 v[4:19], a[120:123], v[76:79], v[4:19]
    v_bfi_b32 v80, v126, s3, v80
    v_bfi_b32 v81, v126, s3, v81
    v_bfi_b32 v82, v126, s3, v82
    v_bfi_b32 v83, v126, s3, v83
    s_nop 1
    v_mfma_f32_32x32x16_bf16 v[4:19], a[124:127], v[80:83], v[4:19]
    s_nop 11
    v_cvt_pk_bf16_f32 v20, v4, v5
    v_cvt_pk_bf16_f32 v21, v6, v7
    v_cvt_pk_bf16_f32 v22, v8, v9
    v_cvt_pk_bf16_f32 v23, v10, v11
    ds_write_b128 v104, v[20:23] offset:0
    v_cvt_pk_bf16_f32 v24, v12, v13
    v_cvt_pk_bf16_f32 v25, v14, v15
    v_cvt_pk_bf16_f32 v26, v16, v17
    v_cvt_pk_bf16_f32 v27, v18, v19
    ds_write_b128 v104, v[24:27] offset:16
    ds_read_b128 v[36:39], v105
    ds_read_b128 v[40:43], v105 offset:1280
    s_waitcnt lgkmcnt(1)
    buffer_store_dwordx4 v[36:39], v106, s[48:51], s72 offen sc0 sc1
    s_waitcnt lgkmcnt(0)
    buffer_store_dwordx4 v[40:43], v106, s[48:51], s65 offen sc0 sc1
    s_endpgm
Lrt_52:
    s_cmp_eq_u32 s68, 0
    s_cbranch_scc1 Lrk_53
    s_sub_u32 s68, s68, 1
    s_sleep 6
    s_add_u32 m0, s72, 0
    s_add_u32 s69, s77, 0
    buffer_load_dwordx4 v96, s[52:55], s69 offen sc0 sc1 lds
    s_add_u32 s69, s69, 592896
    buffer_load_dwordx4 v96, s[52:55], s69 offen offset:1024 sc0 sc1 lds
    s_add_u32 m0, s72, 2048
    s_add_u32 s69, s77, 1187840
    buffer_load_dwordx4 v96, s[52:55], s69 offen sc0 sc1 lds
    s_add_u32 s69, s69, 592896
    buffer_load_dwordx4 v96, s[52:55], s69 offen offset:1024 sc0 sc1 lds
    s_waitcnt vmcnt(2)
    s_branch Lxc_51
Lrt_55:
    s_cmp_eq_u32 s68, 0
    s_cbranch_scc1 Lrk_56
    s_sub_u32 s68, s68, 1
    s_sleep 6
    s_add_u32 m0, s72, 2048
    s_add_u32 s69, s77, 1187840
    buffer_load_dwordx4 v96, s[52:55], s69 offen sc0 sc1 lds
    s_add_u32 s69, s69, 592896
    buffer_load_dwordx4 v96, s[52:55], s69 offen offset:1024 sc0 sc1 lds
    s_waitcnt vmcnt(0)
    s_branch Lxc_54
Lrt_63:
    s_cmp_eq_u32 s68, 0
    s_cbranch_scc1 Lrk_64
    s_sub_u32 s68, s68, 1
    s_sleep 6
    s_mov_b32 m0, s72
    s_mov_b32 s69, s73
    buffer_load_dwordx4 v100, s[52:55], s69 offen sc0 sc1 lds
    buffer_load_dwordx4 v100, s[52:55], s69 offen offset:1024 sc0 sc1 lds
    buffer_load_dwordx4 v100, s[52:55], s69 offen offset:2048 sc0 sc1 lds
    buffer_load_dwordx4 v100, s[52:55], s69 offen offset:3072 sc0 sc1 lds
    s_waitcnt vmcnt(0)
    s_branch Lpc_62
Lrt_67:
    s_cmp_eq_u32 s68, 0
    s_cbranch_scc1 Lrk_68
    s_sub_u32 s68, s68, 1
    s_sleep 6
    buffer_load_dwordx2 v[16:17], v15, s[52:55], s77 offen sc0 sc1
    s_waitcnt vmcnt(0)
    s_branch Lzc_66
Lrt_72:
    s_cmp_eq_u32 s68, 0
    s_cbranch_scc1 Lrk_73
    s_sub_u32 s68, s68, 1
    s_sleep 10
    s_add_u32 m0, s79, 98304
    s_add_u32 s69, s73, 0
    buffer_load_dwordx4 v127, s[52:55], s69 offen sc0 sc1 lds
    buffer_load_dwordx4 v127, s[52:55], s69 offen offset:1024 sc0 sc1 lds
    buffer_load_dwordx4 v127, s[52:55], s69 offen offset:2048 sc0 sc1 lds
    buffer_load_dwordx4 v127, s[52:55], s69 offen offset:3072 sc0 sc1 lds
    s_waitcnt vmcnt(0)
    s_branch Loc_71
Lrt_75:
    s_cmp_eq_u32 s68, 0
    s_cbranch_scc1 Lrk_76
    s_sub_u32 s68, s68, 1
    s_sleep 10
    s_add_u32 m0, s79, 114688
    s_add_u32 s69, s73, 16384
    buffer_load_dwordx4 v127, s[52:55], s69 offen sc0 sc1 lds
    buffer_load_dwordx4 v127, s[52:55], s69 offen offset:1024 sc0 sc1 lds
    buffer_load_dwordx4 v127, s[52:55], s69 offen offset:2048 sc0 sc1 lds
    buffer_load_dwordx4 v127, s[52:55], s69 offen offset:3072 sc0 sc1 lds
    s_waitcnt vmcnt(0)
    s_branch Loc_74
L_end:
    s_endpgm
.section .rodata,"a"
.p2align 6
.amdhsa_kernel concat_heads__spectral_gfnet__linear_attn_block__prompt_kernel
  .amdhsa_next_free_vgpr 256
  .amdhsa_next_free_sgpr 96
  .amdhsa_accum_offset 128
  .amdhsa_group_segment_fixed_size 0
  .amdhsa_kernarg_size 72
  .amdhsa_user_sgpr_count 2
  .amdhsa_user_sgpr_kernarg_segment_ptr 1
  .amdhsa_system_sgpr_workgroup_id_x 1
.end_amdhsa_kernel
```
